```python
import torch

def _softmax(x, axis=-1):
    return torch.softmax(x, dim=axis)
def _gelu(x):
    return torch.nn.functional.gelu(x, approximate="tanh")
def _silu(x):
    return torch.nn.functional.silu(x)
def _sigmoid(x):
    return torch.sigmoid(x)
def _layernorm(x, axis=-1, eps=1e-5):
    m = x.mean(dim=axis, keepdim=True)
    v = x.var(dim=axis, keepdim=True, unbiased=False)
    return (x - m) / torch.sqrt(v + eps)
def _scatter_add(tgt, idx, src, axis=0):
    return tgt.clone().index_add_(axis, idx, src)
def _segment_sum(src, seg, n):
    out = torch.zeros((n,) + src.shape[1:], dtype=src.dtype)
    return out.index_add_(0, seg, src)
def _pad(x, pw):
    flat = tuple(v for pair in reversed(pw) for v in pair)
    return torch.nn.functional.pad(x, flat)

kernel_name = 'sequential_preLN__spectral_fnet__dense_activation_relu__prompt'

def setup_inputs():

    _w = (lambda a: (lambda t: t.to(torch.bfloat16) if t.is_floating_point() else t)(torch.as_tensor(a)))
    def _A_setup():
        B, S, D = 1, 2048, 640
        ns = torch.arange(S)[:, None] * torch.arange(S)[None, :]
        nd = torch.arange(D)[:, None] * torch.arange(D)[None, :]
        Ws_re = torch.cos(-2.0 * torch.pi * ns / S).to(float)
        Ws_im = torch.sin(-2.0 * torch.pi * ns / S).to(float)
        Wd_re = torch.cos(-2.0 * torch.pi * nd / D).to(float)
        Wd_im = torch.sin(-2.0 * torch.pi * nd / D).to(float)
        return {
            "x": _w((lambda *s: torch.randn(*s, dtype=torch.bfloat16) * 0.05)(B, S, D)),
            "dft_seq_re": _w(Ws_re),
            "dft_seq_im": _w(Ws_im),
            "dft_hid_re": _w(Wd_re),
            "dft_hid_im": _w(Wd_im),
        }
    _A_in = _A_setup()

    def _B_setup():
        B, S, D, Dff = 1, 2048, 640, 1728
        return {
            "x": _w((lambda *s: torch.randn(*s, dtype=torch.bfloat16) * 0.05)(B, S, D)),
            "w1": _w((lambda *s: torch.randn(*s, dtype=torch.bfloat16) * 0.4)(D, Dff)),
            "w2": _w((lambda *s: torch.randn(*s, dtype=torch.bfloat16) * 0.4)(Dff, D)),
        }
    _B_in = _B_setup()

    return {
        "A_x": _A_in["x"],
        "A_dft_seq_re": _A_in["dft_seq_re"],
        "A_dft_seq_im": _A_in["dft_seq_im"],
        "A_dft_hid_re": _A_in["dft_hid_re"],
        "A_dft_hid_im": _A_in["dft_hid_im"],
        "B_x": _B_in["x"],
        "B_w1": _B_in["w1"],
        "B_w2": _B_in["w2"],
    }

def reference(A_x, A_dft_seq_re, A_dft_seq_im, A_dft_hid_re, A_dft_hid_im, B_x, B_w1, B_w2):
    def _A_ref(x, dft_seq_re, dft_seq_im, dft_hid_re, dft_hid_im):
        a = torch.einsum("bsd,ed->bse", x, dft_hid_re)
        b = torch.einsum("bsd,ed->bse", x, dft_hid_im)
        y = torch.einsum("ts,bse->bte", dft_seq_re, a) - torch.einsum("ts,bse->bte", dft_seq_im, b)
        return y

    def _B_ref(x, w1, w2):
        h = torch.einsum("bsd,df->bsf", x, w1)
        zero = torch.zeros_like(h)
        h = torch.maximum(h, zero)
        return torch.einsum("bsf,fd->bsd", h, w2)

    x = A_x
    h = x + _A_ref(_layernorm(x, axis=-1), A_dft_seq_re, A_dft_seq_im, A_dft_hid_re, A_dft_hid_im)
    h2 = h + _B_ref(_layernorm(h, axis=-1), B_w1, B_w2)
    return h2
```

```asm
; @launch grid=(256,1,1) block=(256,1,1) lds=163840
.amdgcn_target "amdgcn-amd-amdhsa--gfx950"
.text
.globl sequential_preLN__spectral_fnet__dense_activation_relu__prompt_kernel
.p2align 12
.p2align 8
.type sequential_preLN__spectral_fnet__dense_activation_relu__prompt_kernel,@function
sequential_preLN__spectral_fnet__dense_activation_relu__prompt_kernel:
    s_cmp_ge_u32 s2, 256
    s_cbranch_scc1 L_end
    s_load_dwordx2 s[4:5], s[0:1], 0
    s_load_dwordx2 s[28:29], s[0:1], 80
    s_load_dwordx2 s[8:9], s[0:1], 48
    s_load_dwordx2 s[12:13], s[0:1], 56
    s_load_dwordx2 s[32:33], s[0:1], 64
    s_getpc_b64 s[58:59]
L_pc:
    v_lshlrev_b32 v4, 7, v0
    v_min_u32 v4, L_end-L_pc, v4
    v_mov_b32 v5, s59
    v_add_co_u32 v4, vcc, s58, v4
    s_nop 1
    v_addc_co_u32 v5, vcc, 0, v5, vcc
    global_load_dword v15, v[4:5], off
    s_mov_b32 s6, 2621440
    s_mov_b32 s7, 0x20000
    v_lshrrev_b32 v1, 6, v0
    s_nop 0
    v_readfirstlane_b32 s3, v1
    v_and_b32 v1, 63, v0
    v_and_b32 v3, 15, v0
    v_bfe_u32 v4, v0, 4, 2
    s_and_b32 s36, s2, 7
    s_lshl_b32 s36, s36, 3
    s_lshr_b32 s39, s2, 5
    s_add_u32 s36, s36, s39
    s_bfe_u32 s37, s2, 0x10003
    s_bfe_u32 s38, s2, 0x10004
    s_mul_i32 s40, s36, 1280
    s_mul_i32 s41, s38, 5
    s_add_u32 s43, s41, 4
    s_sub_u32 s43, s43, s3
    s_add_u32 s41, s41, s3
    v_lshrrev_b32 v5, 3, v0
    v_and_b32 v6, 7, v0
    v_mul_u32_u24 v2, 81920, v5
    v_lshl_add_u32 v2, v6, 4, v2
    s_cmp_eq_u32 s3, 3
    s_cselect_b32 s68, 1, 0
    s_cmp_eq_u32 s68, 1
    s_cbranch_scc0 L_units
    s_lshr_b32 s54, s2, 3
    s_mul_i32 s54, s54, 69120
    s_and_b32 s55, s2, 1
    s_mul_i32 s42, s55, 1728
    s_add_u32 s54, s54, s42
    s_mul_i32 s42, s55, -312
    s_add_u32 s42, s42, 4682
    s_mul_i32 s55, s55, -128
    s_add_u32 s55, s55, 1664
    v_add_u32 v56, 0, v1
    v_mul_u32_u24 v57, s42, v56
    v_lshrrev_b32 v57, 16, v57
    v_mul_u32_u24 v58, s55, v57
    v_lshl_add_u32 v144, v56, 7, v58
    v_add_u32 v56, 64, v1
    v_mul_u32_u24 v57, s42, v56
    v_lshrrev_b32 v57, 16, v57
    v_mul_u32_u24 v58, s55, v57
    v_lshl_add_u32 v145, v56, 7, v58
    v_add_u32 v56, 128, v1
    v_mul_u32_u24 v57, s42, v56
    v_lshrrev_b32 v57, 16, v57
    v_mul_u32_u24 v58, s55, v57
    v_lshl_add_u32 v146, v56, 7, v58
    v_add_u32 v56, 192, v1
    v_mul_u32_u24 v57, s42, v56
    v_lshrrev_b32 v57, 16, v57
    v_mul_u32_u24 v58, s55, v57
    v_lshl_add_u32 v147, v56, 7, v58
    v_add_u32 v56, 256, v1
    v_mul_u32_u24 v57, s42, v56
    v_lshrrev_b32 v57, 16, v57
    v_mul_u32_u24 v58, s55, v57
    v_lshl_add_u32 v148, v56, 7, v58
    s_mov_b32 s10, 2211840
    s_mov_b32 s11, 0x20000
    s_waitcnt lgkmcnt(0)
    buffer_load_dwordx4 v[16:19], v2, s[4:7], s40 offen offset:0
    buffer_load_dwordx4 v[36:39], v2, s[4:7], s40 offen offset:640
    buffer_load_dwordx4 v[20:23], v2, s[4:7], s40 offen offset:128
    buffer_load_dwordx4 v[40:43], v2, s[4:7], s40 offen offset:768
    buffer_load_dwordx4 v[24:27], v2, s[4:7], s40 offen offset:256
    buffer_load_dwordx4 v[44:47], v2, s[4:7], s40 offen offset:896
    buffer_load_dwordx4 v[28:31], v2, s[4:7], s40 offen offset:384
    buffer_load_dwordx4 v[48:51], v2, s[4:7], s40 offen offset:1024
    buffer_load_dwordx4 v[32:35], v2, s[4:7], s40 offen offset:512
    buffer_load_dwordx4 v[52:55], v2, s[4:7], s40 offen offset:1152
    s_add_u32 s56, s28, 26476544
    s_addc_u32 s57, s29, 0
    s_load_dwordx2 s[24:25], s[56:57], 0
    s_branch L_loader0
L_units:
    v_lshlrev_b32 v61, 3, v4
    v_cvt_f32_u32 v58, v61
    s_lshl_b32 s42, s41, 5
    s_add_u32 s42, s42, s37
    v_lshl_add_u32 v59, v3, 1, s42
    v_cmp_eq_u32 vcc, 0, v59
    v_mov_b32 v60, 320
    s_nop 0
    v_cndmask_b32 v59, v59, v60, vcc
    v_cvt_f32_u32 v60, v59
    v_mul_f32 v60, 0xbacccccd, v60
    v_lshlrev_b32 v59, 30, v59
    v_and_b32 v59, 0x80000000, v59
    v_or_b32 v90, 1.0, v59
    v_mul_f32 v61, v58, v60
    v_mul_f32 v59, 0x42000000, v60
    v_fmamk_f32 v62, v60, 0x3f800000, v61
    v_fmamk_f32 v63, v60, 0x40000000, v61
    v_fmamk_f32 v64, v60, 0x40400000, v61
    v_fmamk_f32 v65, v60, 0x40800000, v61
    v_fmamk_f32 v66, v60, 0x40a00000, v61
    v_fmamk_f32 v67, v60, 0x40c00000, v61
    v_fmamk_f32 v68, v60, 0x40e00000, v61
    v_cos_f32 v70, v59
    v_sin_f32 v72, v59
    v_cos_f32 v176, v61
    v_sin_f32 v184, v61
    v_cos_f32 v177, v62
    v_sin_f32 v185, v62
    v_cos_f32 v178, v63
    v_sin_f32 v186, v63
    v_cos_f32 v179, v64
    v_sin_f32 v187, v64
    v_cos_f32 v180, v65
    v_sin_f32 v188, v65
    v_cos_f32 v181, v66
    v_sin_f32 v189, v66
    v_cos_f32 v182, v67
    v_sin_f32 v190, v67
    v_cos_f32 v183, v68
    v_sin_f32 v191, v68
    v_cvt_pk_bf16_f32 v96, v176, v177
    v_cvt_pk_bf16_f32 v116, v184, v185
    v_cvt_pk_bf16_f32 v97, v178, v179
    v_cvt_pk_bf16_f32 v117, v186, v187
    v_cvt_pk_bf16_f32 v98, v180, v181
    v_cvt_pk_bf16_f32 v118, v188, v189
    v_cvt_pk_bf16_f32 v99, v182, v183
    v_cvt_pk_bf16_f32 v119, v190, v191
    s_waitcnt lgkmcnt(0)
    buffer_load_dwordx4 v[16:19], v2, s[4:7], s40 offen offset:0
    buffer_load_dwordx4 v[36:39], v2, s[4:7], s40 offen offset:640
    buffer_load_dwordx4 v[20:23], v2, s[4:7], s40 offen offset:128
    buffer_load_dwordx4 v[40:43], v2, s[4:7], s40 offen offset:768
    buffer_load_dwordx4 v[24:27], v2, s[4:7], s40 offen offset:256
    buffer_load_dwordx4 v[44:47], v2, s[4:7], s40 offen offset:896
    buffer_load_dwordx4 v[28:31], v2, s[4:7], s40 offen offset:384
    buffer_load_dwordx4 v[48:51], v2, s[4:7], s40 offen offset:1024
    buffer_load_dwordx4 v[32:35], v2, s[4:7], s40 offen offset:512
    buffer_load_dwordx4 v[52:55], v2, s[4:7], s40 offen offset:1152
    s_add_u32 s56, s28, 26476544
    s_addc_u32 s57, s29, 0
    s_load_dwordx2 s[24:25], s[56:57], 0
    v_pk_mul_f32 v[192:193], v[176:177], v[72:73] op_sel_hi:[1,0]
    v_pk_mul_f32 v[200:201], v[184:185], v[72:73] op_sel_hi:[1,0]
    v_pk_mul_f32 v[194:195], v[178:179], v[72:73] op_sel_hi:[1,0]
    v_pk_mul_f32 v[202:203], v[186:187], v[72:73] op_sel_hi:[1,0]
    v_pk_mul_f32 v[196:197], v[180:181], v[72:73] op_sel_hi:[1,0]
    v_pk_mul_f32 v[204:205], v[188:189], v[72:73] op_sel_hi:[1,0]
    v_pk_mul_f32 v[198:199], v[182:183], v[72:73] op_sel_hi:[1,0]
    v_pk_mul_f32 v[206:207], v[190:191], v[72:73] op_sel_hi:[1,0]
    v_pk_fma_f32 v[176:177], v[176:177], v[70:71], v[200:201] op_sel_hi:[1,0,1] neg_lo:[0,0,1] neg_hi:[0,0,1]
    v_pk_fma_f32 v[184:185], v[184:185], v[70:71], v[192:193] op_sel_hi:[1,0,1]
    v_pk_fma_f32 v[178:179], v[178:179], v[70:71], v[202:203] op_sel_hi:[1,0,1] neg_lo:[0,0,1] neg_hi:[0,0,1]
    v_pk_fma_f32 v[186:187], v[186:187], v[70:71], v[194:195] op_sel_hi:[1,0,1]
    v_pk_fma_f32 v[180:181], v[180:181], v[70:71], v[204:205] op_sel_hi:[1,0,1] neg_lo:[0,0,1] neg_hi:[0,0,1]
    v_pk_fma_f32 v[188:189], v[188:189], v[70:71], v[196:197] op_sel_hi:[1,0,1]
    v_pk_fma_f32 v[182:183], v[182:183], v[70:71], v[206:207] op_sel_hi:[1,0,1] neg_lo:[0,0,1] neg_hi:[0,0,1]
    v_pk_fma_f32 v[190:191], v[190:191], v[70:71], v[198:199] op_sel_hi:[1,0,1]
    v_cvt_pk_bf16_f32 v100, v176, v177
    v_cvt_pk_bf16_f32 v120, v184, v185
    v_cvt_pk_bf16_f32 v101, v178, v179
    v_cvt_pk_bf16_f32 v121, v186, v187
    v_cvt_pk_bf16_f32 v102, v180, v181
    v_cvt_pk_bf16_f32 v122, v188, v189
    v_cvt_pk_bf16_f32 v103, v182, v183
    v_cvt_pk_bf16_f32 v123, v190, v191
    v_pk_mul_f32 v[192:193], v[176:177], v[72:73] op_sel_hi:[1,0]
    v_pk_mul_f32 v[200:201], v[184:185], v[72:73] op_sel_hi:[1,0]
    v_pk_mul_f32 v[194:195], v[178:179], v[72:73] op_sel_hi:[1,0]
    v_pk_mul_f32 v[202:203], v[186:187], v[72:73] op_sel_hi:[1,0]
    v_pk_mul_f32 v[196:197], v[180:181], v[72:73] op_sel_hi:[1,0]
    v_pk_mul_f32 v[204:205], v[188:189], v[72:73] op_sel_hi:[1,0]
    v_pk_mul_f32 v[198:199], v[182:183], v[72:73] op_sel_hi:[1,0]
    v_pk_mul_f32 v[206:207], v[190:191], v[72:73] op_sel_hi:[1,0]
    v_pk_fma_f32 v[176:177], v[176:177], v[70:71], v[200:201] op_sel_hi:[1,0,1] neg_lo:[0,0,1] neg_hi:[0,0,1]
    v_pk_fma_f32 v[184:185], v[184:185], v[70:71], v[192:193] op_sel_hi:[1,0,1]
    v_pk_fma_f32 v[178:179], v[178:179], v[70:71], v[202:203] op_sel_hi:[1,0,1] neg_lo:[0,0,1] neg_hi:[0,0,1]
    v_pk_fma_f32 v[186:187], v[186:187], v[70:71], v[194:195] op_sel_hi:[1,0,1]
    v_pk_fma_f32 v[180:181], v[180:181], v[70:71], v[204:205] op_sel_hi:[1,0,1] neg_lo:[0,0,1] neg_hi:[0,0,1]
    v_pk_fma_f32 v[188:189], v[188:189], v[70:71], v[196:197] op_sel_hi:[1,0,1]
    v_pk_fma_f32 v[182:183], v[182:183], v[70:71], v[206:207] op_sel_hi:[1,0,1] neg_lo:[0,0,1] neg_hi:[0,0,1]
    v_pk_fma_f32 v[190:191], v[190:191], v[70:71], v[198:199] op_sel_hi:[1,0,1]
    v_cvt_pk_bf16_f32 v104, v176, v177
    v_cvt_pk_bf16_f32 v124, v184, v185
    v_cvt_pk_bf16_f32 v105, v178, v179
    v_cvt_pk_bf16_f32 v125, v186, v187
    v_cvt_pk_bf16_f32 v106, v180, v181
    v_cvt_pk_bf16_f32 v126, v188, v189
    v_cvt_pk_bf16_f32 v107, v182, v183
    v_cvt_pk_bf16_f32 v127, v190, v191
    v_pk_mul_f32 v[192:193], v[176:177], v[72:73] op_sel_hi:[1,0]
    v_pk_mul_f32 v[200:201], v[184:185], v[72:73] op_sel_hi:[1,0]
    v_pk_mul_f32 v[194:195], v[178:179], v[72:73] op_sel_hi:[1,0]
    v_pk_mul_f32 v[202:203], v[186:187], v[72:73] op_sel_hi:[1,0]
    v_pk_mul_f32 v[196:197], v[180:181], v[72:73] op_sel_hi:[1,0]
    v_pk_mul_f32 v[204:205], v[188:189], v[72:73] op_sel_hi:[1,0]
    v_pk_mul_f32 v[198:199], v[182:183], v[72:73] op_sel_hi:[1,0]
    v_pk_mul_f32 v[206:207], v[190:191], v[72:73] op_sel_hi:[1,0]
    v_pk_fma_f32 v[176:177], v[176:177], v[70:71], v[200:201] op_sel_hi:[1,0,1] neg_lo:[0,0,1] neg_hi:[0,0,1]
    v_pk_fma_f32 v[184:185], v[184:185], v[70:71], v[192:193] op_sel_hi:[1,0,1]
    v_pk_fma_f32 v[178:179], v[178:179], v[70:71], v[202:203] op_sel_hi:[1,0,1] neg_lo:[0,0,1] neg_hi:[0,0,1]
    v_pk_fma_f32 v[186:187], v[186:187], v[70:71], v[194:195] op_sel_hi:[1,0,1]
    v_pk_fma_f32 v[180:181], v[180:181], v[70:71], v[204:205] op_sel_hi:[1,0,1] neg_lo:[0,0,1] neg_hi:[0,0,1]
    v_pk_fma_f32 v[188:189], v[188:189], v[70:71], v[196:197] op_sel_hi:[1,0,1]
    v_pk_fma_f32 v[182:183], v[182:183], v[70:71], v[206:207] op_sel_hi:[1,0,1] neg_lo:[0,0,1] neg_hi:[0,0,1]
    v_pk_fma_f32 v[190:191], v[190:191], v[70:71], v[198:199] op_sel_hi:[1,0,1]
    v_cvt_pk_bf16_f32 v108, v176, v177
    v_cvt_pk_bf16_f32 v128, v184, v185
    v_cvt_pk_bf16_f32 v109, v178, v179
    v_cvt_pk_bf16_f32 v129, v186, v187
    v_cvt_pk_bf16_f32 v110, v180, v181
    v_cvt_pk_bf16_f32 v130, v188, v189
    v_cvt_pk_bf16_f32 v111, v182, v183
    v_cvt_pk_bf16_f32 v131, v190, v191
    v_pk_mul_f32 v[192:193], v[176:177], v[72:73] op_sel_hi:[1,0]
    v_pk_mul_f32 v[200:201], v[184:185], v[72:73] op_sel_hi:[1,0]
    v_pk_mul_f32 v[194:195], v[178:179], v[72:73] op_sel_hi:[1,0]
    v_pk_mul_f32 v[202:203], v[186:187], v[72:73] op_sel_hi:[1,0]
    v_pk_mul_f32 v[196:197], v[180:181], v[72:73] op_sel_hi:[1,0]
    v_pk_mul_f32 v[204:205], v[188:189], v[72:73] op_sel_hi:[1,0]
    v_pk_mul_f32 v[198:199], v[182:183], v[72:73] op_sel_hi:[1,0]
    v_pk_mul_f32 v[206:207], v[190:191], v[72:73] op_sel_hi:[1,0]
    v_pk_fma_f32 v[176:177], v[176:177], v[70:71], v[200:201] op_sel_hi:[1,0,1] neg_lo:[0,0,1] neg_hi:[0,0,1]
    v_pk_fma_f32 v[184:185], v[184:185], v[70:71], v[192:193] op_sel_hi:[1,0,1]
    v_pk_fma_f32 v[178:179], v[178:179], v[70:71], v[202:203] op_sel_hi:[1,0,1] neg_lo:[0,0,1] neg_hi:[0,0,1]
    v_pk_fma_f32 v[186:187], v[186:187], v[70:71], v[194:195] op_sel_hi:[1,0,1]
    v_pk_fma_f32 v[180:181], v[180:181], v[70:71], v[204:205] op_sel_hi:[1,0,1] neg_lo:[0,0,1] neg_hi:[0,0,1]
    v_pk_fma_f32 v[188:189], v[188:189], v[70:71], v[196:197] op_sel_hi:[1,0,1]
    v_pk_fma_f32 v[182:183], v[182:183], v[70:71], v[206:207] op_sel_hi:[1,0,1] neg_lo:[0,0,1] neg_hi:[0,0,1]
    v_pk_fma_f32 v[190:191], v[190:191], v[70:71], v[198:199] op_sel_hi:[1,0,1]
    v_cvt_pk_bf16_f32 v112, v176, v177
    v_cvt_pk_bf16_f32 v132, v184, v185
    v_cvt_pk_bf16_f32 v113, v178, v179
    v_cvt_pk_bf16_f32 v133, v186, v187
    v_cvt_pk_bf16_f32 v114, v180, v181
    v_cvt_pk_bf16_f32 v134, v188, v189
    v_cvt_pk_bf16_f32 v115, v182, v183
    v_cvt_pk_bf16_f32 v135, v190, v191
    s_cmp_eq_u32 s3, 2
    s_cbranch_scc1 L_gend
    s_lshl_b32 s42, s43, 5
    s_add_u32 s42, s42, s37
    v_lshl_add_u32 v59, v3, 1, s42
    v_cmp_eq_u32 vcc, 0, v59
    v_mov_b32 v60, 320
    s_nop 0
    v_cndmask_b32 v59, v59, v60, vcc
    v_cvt_f32_u32 v60, v59
    v_mul_f32 v60, 0xbacccccd, v60
    v_lshlrev_b32 v59, 30, v59
    v_and_b32 v59, 0x80000000, v59
    v_or_b32 v91, 1.0, v59
    v_mul_f32 v61, v58, v60
    v_mul_f32 v59, 0x42000000, v60
    v_fmamk_f32 v62, v60, 0x3f800000, v61
    v_fmamk_f32 v63, v60, 0x40000000, v61
    v_fmamk_f32 v64, v60, 0x40400000, v61
    v_fmamk_f32 v65, v60, 0x40800000, v61
    v_fmamk_f32 v66, v60, 0x40a00000, v61
    v_fmamk_f32 v67, v60, 0x40c00000, v61
    v_fmamk_f32 v68, v60, 0x40e00000, v61
    v_cos_f32 v70, v59
    v_sin_f32 v72, v59
    v_cos_f32 v176, v61
    v_sin_f32 v184, v61
    v_cos_f32 v177, v62
    v_sin_f32 v185, v62
    v_cos_f32 v178, v63
    v_sin_f32 v186, v63
    v_cos_f32 v179, v64
    v_sin_f32 v187, v64
    v_cos_f32 v180, v65
    v_sin_f32 v188, v65
    v_cos_f32 v181, v66
    v_sin_f32 v189, v66
    v_cos_f32 v182, v67
    v_sin_f32 v190, v67
    v_cos_f32 v183, v68
    v_sin_f32 v191, v68
    v_cvt_pk_bf16_f32 v136, v176, v177
    v_cvt_pk_bf16_f32 v156, v184, v185
    v_cvt_pk_bf16_f32 v137, v178, v179
    v_cvt_pk_bf16_f32 v157, v186, v187
    v_cvt_pk_bf16_f32 v138, v180, v181
    v_cvt_pk_bf16_f32 v158, v188, v189
    v_cvt_pk_bf16_f32 v139, v182, v183
    v_cvt_pk_bf16_f32 v159, v190, v191
    v_pk_mul_f32 v[192:193], v[176:177], v[72:73] op_sel_hi:[1,0]
    v_pk_mul_f32 v[200:201], v[184:185], v[72:73] op_sel_hi:[1,0]
    v_pk_mul_f32 v[194:195], v[178:179], v[72:73] op_sel_hi:[1,0]
    v_pk_mul_f32 v[202:203], v[186:187], v[72:73] op_sel_hi:[1,0]
    v_pk_mul_f32 v[196:197], v[180:181], v[72:73] op_sel_hi:[1,0]
    v_pk_mul_f32 v[204:205], v[188:189], v[72:73] op_sel_hi:[1,0]
    v_pk_mul_f32 v[198:199], v[182:183], v[72:73] op_sel_hi:[1,0]
    v_pk_mul_f32 v[206:207], v[190:191], v[72:73] op_sel_hi:[1,0]
    v_pk_fma_f32 v[176:177], v[176:177], v[70:71], v[200:201] op_sel_hi:[1,0,1] neg_lo:[0,0,1] neg_hi:[0,0,1]
    v_pk_fma_f32 v[184:185], v[184:185], v[70:71], v[192:193] op_sel_hi:[1,0,1]
    v_pk_fma_f32 v[178:179], v[178:179], v[70:71], v[202:203] op_sel_hi:[1,0,1] neg_lo:[0,0,1] neg_hi:[0,0,1]
    v_pk_fma_f32 v[186:187], v[186:187], v[70:71], v[194:195] op_sel_hi:[1,0,1]
    v_pk_fma_f32 v[180:181], v[180:181], v[70:71], v[204:205] op_sel_hi:[1,0,1] neg_lo:[0,0,1] neg_hi:[0,0,1]
    v_pk_fma_f32 v[188:189], v[188:189], v[70:71], v[196:197] op_sel_hi:[1,0,1]
    v_pk_fma_f32 v[182:183], v[182:183], v[70:71], v[206:207] op_sel_hi:[1,0,1] neg_lo:[0,0,1] neg_hi:[0,0,1]
    v_pk_fma_f32 v[190:191], v[190:191], v[70:71], v[198:199] op_sel_hi:[1,0,1]
    v_cvt_pk_bf16_f32 v140, v176, v177
    v_cvt_pk_bf16_f32 v160, v184, v185
    v_cvt_pk_bf16_f32 v141, v178, v179
    v_cvt_pk_bf16_f32 v161, v186, v187
    v_cvt_pk_bf16_f32 v142, v180, v181
    v_cvt_pk_bf16_f32 v162, v188, v189
    v_cvt_pk_bf16_f32 v143, v182, v183
    v_cvt_pk_bf16_f32 v163, v190, v191
    v_pk_mul_f32 v[192:193], v[176:177], v[72:73] op_sel_hi:[1,0]
    v_pk_mul_f32 v[200:201], v[184:185], v[72:73] op_sel_hi:[1,0]
    v_pk_mul_f32 v[194:195], v[178:179], v[72:73] op_sel_hi:[1,0]
    v_pk_mul_f32 v[202:203], v[186:187], v[72:73] op_sel_hi:[1,0]
    v_pk_mul_f32 v[196:197], v[180:181], v[72:73] op_sel_hi:[1,0]
    v_pk_mul_f32 v[204:205], v[188:189], v[72:73] op_sel_hi:[1,0]
    v_pk_mul_f32 v[198:199], v[182:183], v[72:73] op_sel_hi:[1,0]
    v_pk_mul_f32 v[206:207], v[190:191], v[72:73] op_sel_hi:[1,0]
    v_pk_fma_f32 v[176:177], v[176:177], v[70:71], v[200:201] op_sel_hi:[1,0,1] neg_lo:[0,0,1] neg_hi:[0,0,1]
    v_pk_fma_f32 v[184:185], v[184:185], v[70:71], v[192:193] op_sel_hi:[1,0,1]
    v_pk_fma_f32 v[178:179], v[178:179], v[70:71], v[202:203] op_sel_hi:[1,0,1] neg_lo:[0,0,1] neg_hi:[0,0,1]
    v_pk_fma_f32 v[186:187], v[186:187], v[70:71], v[194:195] op_sel_hi:[1,0,1]
    v_pk_fma_f32 v[180:181], v[180:181], v[70:71], v[204:205] op_sel_hi:[1,0,1] neg_lo:[0,0,1] neg_hi:[0,0,1]
    v_pk_fma_f32 v[188:189], v[188:189], v[70:71], v[196:197] op_sel_hi:[1,0,1]
    v_pk_fma_f32 v[182:183], v[182:183], v[70:71], v[206:207] op_sel_hi:[1,0,1] neg_lo:[0,0,1] neg_hi:[0,0,1]
    v_pk_fma_f32 v[190:191], v[190:191], v[70:71], v[198:199] op_sel_hi:[1,0,1]
    v_cvt_pk_bf16_f32 v144, v176, v177
    v_cvt_pk_bf16_f32 v164, v184, v185
    v_cvt_pk_bf16_f32 v145, v178, v179
    v_cvt_pk_bf16_f32 v165, v186, v187
    v_cvt_pk_bf16_f32 v146, v180, v181
    v_cvt_pk_bf16_f32 v166, v188, v189
    v_cvt_pk_bf16_f32 v147, v182, v183
    v_cvt_pk_bf16_f32 v167, v190, v191
    v_pk_mul_f32 v[192:193], v[176:177], v[72:73] op_sel_hi:[1,0]
    v_pk_mul_f32 v[200:201], v[184:185], v[72:73] op_sel_hi:[1,0]
    v_pk_mul_f32 v[194:195], v[178:179], v[72:73] op_sel_hi:[1,0]
    v_pk_mul_f32 v[202:203], v[186:187], v[72:73] op_sel_hi:[1,0]
    v_pk_mul_f32 v[196:197], v[180:181], v[72:73] op_sel_hi:[1,0]
    v_pk_mul_f32 v[204:205], v[188:189], v[72:73] op_sel_hi:[1,0]
    v_pk_mul_f32 v[198:199], v[182:183], v[72:73] op_sel_hi:[1,0]
    v_pk_mul_f32 v[206:207], v[190:191], v[72:73] op_sel_hi:[1,0]
    v_pk_fma_f32 v[176:177], v[176:177], v[70:71], v[200:201] op_sel_hi:[1,0,1] neg_lo:[0,0,1] neg_hi:[0,0,1]
    v_pk_fma_f32 v[184:185], v[184:185], v[70:71], v[192:193] op_sel_hi:[1,0,1]
    v_pk_fma_f32 v[178:179], v[178:179], v[70:71], v[202:203] op_sel_hi:[1,0,1] neg_lo:[0,0,1] neg_hi:[0,0,1]
    v_pk_fma_f32 v[186:187], v[186:187], v[70:71], v[194:195] op_sel_hi:[1,0,1]
    v_pk_fma_f32 v[180:181], v[180:181], v[70:71], v[204:205] op_sel_hi:[1,0,1] neg_lo:[0,0,1] neg_hi:[0,0,1]
    v_pk_fma_f32 v[188:189], v[188:189], v[70:71], v[196:197] op_sel_hi:[1,0,1]
    v_pk_fma_f32 v[182:183], v[182:183], v[70:71], v[206:207] op_sel_hi:[1,0,1] neg_lo:[0,0,1] neg_hi:[0,0,1]
    v_pk_fma_f32 v[190:191], v[190:191], v[70:71], v[198:199] op_sel_hi:[1,0,1]
    v_cvt_pk_bf16_f32 v148, v176, v177
    v_cvt_pk_bf16_f32 v168, v184, v185
    v_cvt_pk_bf16_f32 v149, v178, v179
    v_cvt_pk_bf16_f32 v169, v186, v187
    v_cvt_pk_bf16_f32 v150, v180, v181
    v_cvt_pk_bf16_f32 v170, v188, v189
    v_cvt_pk_bf16_f32 v151, v182, v183
    v_cvt_pk_bf16_f32 v171, v190, v191
    v_pk_mul_f32 v[192:193], v[176:177], v[72:73] op_sel_hi:[1,0]
    v_pk_mul_f32 v[200:201], v[184:185], v[72:73] op_sel_hi:[1,0]
    v_pk_mul_f32 v[194:195], v[178:179], v[72:73] op_sel_hi:[1,0]
    v_pk_mul_f32 v[202:203], v[186:187], v[72:73] op_sel_hi:[1,0]
    v_pk_mul_f32 v[196:197], v[180:181], v[72:73] op_sel_hi:[1,0]
    v_pk_mul_f32 v[204:205], v[188:189], v[72:73] op_sel_hi:[1,0]
    v_pk_mul_f32 v[198:199], v[182:183], v[72:73] op_sel_hi:[1,0]
    v_pk_mul_f32 v[206:207], v[190:191], v[72:73] op_sel_hi:[1,0]
    v_pk_fma_f32 v[176:177], v[176:177], v[70:71], v[200:201] op_sel_hi:[1,0,1] neg_lo:[0,0,1] neg_hi:[0,0,1]
    v_pk_fma_f32 v[184:185], v[184:185], v[70:71], v[192:193] op_sel_hi:[1,0,1]
    v_pk_fma_f32 v[178:179], v[178:179], v[70:71], v[202:203] op_sel_hi:[1,0,1] neg_lo:[0,0,1] neg_hi:[0,0,1]
    v_pk_fma_f32 v[186:187], v[186:187], v[70:71], v[194:195] op_sel_hi:[1,0,1]
    v_pk_fma_f32 v[180:181], v[180:181], v[70:71], v[204:205] op_sel_hi:[1,0,1] neg_lo:[0,0,1] neg_hi:[0,0,1]
    v_pk_fma_f32 v[188:189], v[188:189], v[70:71], v[196:197] op_sel_hi:[1,0,1]
    v_pk_fma_f32 v[182:183], v[182:183], v[70:71], v[206:207] op_sel_hi:[1,0,1] neg_lo:[0,0,1] neg_hi:[0,0,1]
    v_pk_fma_f32 v[190:191], v[190:191], v[70:71], v[198:199] op_sel_hi:[1,0,1]
    v_cvt_pk_bf16_f32 v152, v176, v177
    v_cvt_pk_bf16_f32 v172, v184, v185
    v_cvt_pk_bf16_f32 v153, v178, v179
    v_cvt_pk_bf16_f32 v173, v186, v187
    v_cvt_pk_bf16_f32 v154, v180, v181
    v_cvt_pk_bf16_f32 v174, v188, v189
    v_cvt_pk_bf16_f32 v155, v182, v183
    v_cvt_pk_bf16_f32 v175, v190, v191
L_gend:
    v_bfe_u32 v7, v5, 1, 2
    v_lshlrev_b32 v7, 1, v7
    v_xor_b32 v7, v7, v6
    v_mul_u32_u24 v2, 640, v5
    v_lshl_add_u32 v2, v7, 4, v2
    v_add_u32 v2, 143360, v2
    s_mov_b32 s50, 0xffff0000
    s_mov_b32 s30, 50331648
    s_mov_b32 s31, 0x20000
    s_mov_b32 s10, 2211840
    s_mov_b32 s11, 0x20000
    s_mov_b32 s14, 2211840
    s_mov_b32 s15, 0x20000
    s_mov_b32 s34, 2621440
    s_mov_b32 s35, 0x20000
    v_bfe_u32 v7, v3, 1, 2
    v_lshlrev_b32 v7, 1, v7
    v_xor_b32 v7, v7, v4
    v_mul_u32_u24 v9, 640, v3
    v_add_u32 v9, 143360, v9
    v_xor_b32 v8, 4, v7
    v_lshl_add_u32 v7, v7, 4, v9
    v_lshl_add_u32 v8, v8, 4, v9
    s_waitcnt vmcnt(9)
    v_lshlrev_b32 v176, 16, v16
    v_and_b32 v177, s50, v16
    v_lshlrev_b32 v178, 16, v17
    v_and_b32 v179, s50, v17
    v_lshlrev_b32 v180, 16, v18
    v_and_b32 v181, s50, v18
    v_lshlrev_b32 v182, 16, v19
    v_and_b32 v183, s50, v19
    v_pk_mul_f32 v[60:61], v[176:177], v[176:177]
    v_pk_mul_f32 v[62:63], v[178:179], v[178:179]
    v_pk_add_f32 v[56:57], v[176:177], v[180:181]
    v_pk_fma_f32 v[60:61], v[180:181], v[180:181], v[60:61]
    v_pk_add_f32 v[58:59], v[178:179], v[182:183]
    v_pk_fma_f32 v[62:63], v[182:183], v[182:183], v[62:63]
    s_waitcnt vmcnt(8)
    v_lshlrev_b32 v216, 16, v36
    v_and_b32 v217, s50, v36
    v_lshlrev_b32 v218, 16, v37
    v_and_b32 v219, s50, v37
    v_lshlrev_b32 v220, 16, v38
    v_and_b32 v221, s50, v38
    v_lshlrev_b32 v222, 16, v39
    v_and_b32 v223, s50, v39
    v_pk_add_f32 v[56:57], v[56:57], v[216:217]
    v_pk_fma_f32 v[60:61], v[216:217], v[216:217], v[60:61]
    v_pk_add_f32 v[58:59], v[58:59], v[218:219]
    v_pk_fma_f32 v[62:63], v[218:219], v[218:219], v[62:63]
    v_pk_add_f32 v[56:57], v[56:57], v[220:221]
    v_pk_fma_f32 v[60:61], v[220:221], v[220:221], v[60:61]
    v_pk_add_f32 v[58:59], v[58:59], v[222:223]
    v_pk_fma_f32 v[62:63], v[222:223], v[222:223], v[62:63]
    s_waitcnt vmcnt(7)
    v_lshlrev_b32 v184, 16, v20
    v_and_b32 v185, s50, v20
    v_lshlrev_b32 v186, 16, v21
    v_and_b32 v187, s50, v21
    v_lshlrev_b32 v188, 16, v22
    v_and_b32 v189, s50, v22
    v_lshlrev_b32 v190, 16, v23
    v_and_b32 v191, s50, v23
    v_pk_add_f32 v[56:57], v[56:57], v[184:185]
    v_pk_fma_f32 v[60:61], v[184:185], v[184:185], v[60:61]
    v_pk_add_f32 v[58:59], v[58:59], v[186:187]
    v_pk_fma_f32 v[62:63], v[186:187], v[186:187], v[62:63]
    v_pk_add_f32 v[56:57], v[56:57], v[188:189]
    v_pk_fma_f32 v[60:61], v[188:189], v[188:189], v[60:61]
    v_pk_add_f32 v[58:59], v[58:59], v[190:191]
    v_pk_fma_f32 v[62:63], v[190:191], v[190:191], v[62:63]
    s_waitcnt vmcnt(6)
    v_lshlrev_b32 v224, 16, v40
    v_and_b32 v225, s50, v40
    v_lshlrev_b32 v226, 16, v41
    v_and_b32 v227, s50, v41
    v_lshlrev_b32 v228, 16, v42
    v_and_b32 v229, s50, v42
    v_lshlrev_b32 v230, 16, v43
    v_and_b32 v231, s50, v43
    v_pk_add_f32 v[56:57], v[56:57], v[224:225]
    v_pk_fma_f32 v[60:61], v[224:225], v[224:225], v[60:61]
    v_pk_add_f32 v[58:59], v[58:59], v[226:227]
    v_pk_fma_f32 v[62:63], v[226:227], v[226:227], v[62:63]
    v_pk_add_f32 v[56:57], v[56:57], v[228:229]
    v_pk_fma_f32 v[60:61], v[228:229], v[228:229], v[60:61]
    v_pk_add_f32 v[58:59], v[58:59], v[230:231]
    v_pk_fma_f32 v[62:63], v[230:231], v[230:231], v[62:63]
    s_waitcnt vmcnt(5)
    v_lshlrev_b32 v192, 16, v24
    v_and_b32 v193, s50, v24
    v_lshlrev_b32 v194, 16, v25
    v_and_b32 v195, s50, v25
    v_lshlrev_b32 v196, 16, v26
    v_and_b32 v197, s50, v26
    v_lshlrev_b32 v198, 16, v27
    v_and_b32 v199, s50, v27
    v_pk_add_f32 v[56:57], v[56:57], v[192:193]
    v_pk_fma_f32 v[60:61], v[192:193], v[192:193], v[60:61]
    v_pk_add_f32 v[58:59], v[58:59], v[194:195]
    v_pk_fma_f32 v[62:63], v[194:195], v[194:195], v[62:63]
    v_pk_add_f32 v[56:57], v[56:57], v[196:197]
    v_pk_fma_f32 v[60:61], v[196:197], v[196:197], v[60:61]
    v_pk_add_f32 v[58:59], v[58:59], v[198:199]
    v_pk_fma_f32 v[62:63], v[198:199], v[198:199], v[62:63]
    s_waitcnt vmcnt(4)
    v_lshlrev_b32 v232, 16, v44
    v_and_b32 v233, s50, v44
    v_lshlrev_b32 v234, 16, v45
    v_and_b32 v235, s50, v45
    v_lshlrev_b32 v236, 16, v46
    v_and_b32 v237, s50, v46
    v_lshlrev_b32 v238, 16, v47
    v_and_b32 v239, s50, v47
    v_pk_add_f32 v[56:57], v[56:57], v[232:233]
    v_pk_fma_f32 v[60:61], v[232:233], v[232:233], v[60:61]
    v_pk_add_f32 v[58:59], v[58:59], v[234:235]
    v_pk_fma_f32 v[62:63], v[234:235], v[234:235], v[62:63]
    v_pk_add_f32 v[56:57], v[56:57], v[236:237]
    v_pk_fma_f32 v[60:61], v[236:237], v[236:237], v[60:61]
    v_pk_add_f32 v[58:59], v[58:59], v[238:239]
    v_pk_fma_f32 v[62:63], v[238:239], v[238:239], v[62:63]
    s_waitcnt vmcnt(3)
    v_lshlrev_b32 v200, 16, v28
    v_and_b32 v201, s50, v28
    v_lshlrev_b32 v202, 16, v29
    v_and_b32 v203, s50, v29
    v_lshlrev_b32 v204, 16, v30
    v_and_b32 v205, s50, v30
    v_lshlrev_b32 v206, 16, v31
    v_and_b32 v207, s50, v31
    v_pk_add_f32 v[56:57], v[56:57], v[200:201]
    v_pk_fma_f32 v[60:61], v[200:201], v[200:201], v[60:61]
    v_pk_add_f32 v[58:59], v[58:59], v[202:203]
    v_pk_fma_f32 v[62:63], v[202:203], v[202:203], v[62:63]
    v_pk_add_f32 v[56:57], v[56:57], v[204:205]
    v_pk_fma_f32 v[60:61], v[204:205], v[204:205], v[60:61]
    v_pk_add_f32 v[58:59], v[58:59], v[206:207]
    v_pk_fma_f32 v[62:63], v[206:207], v[206:207], v[62:63]
    s_waitcnt vmcnt(2)
    v_lshlrev_b32 v240, 16, v48
    v_and_b32 v241, s50, v48
    v_lshlrev_b32 v242, 16, v49
    v_and_b32 v243, s50, v49
    v_lshlrev_b32 v244, 16, v50
    v_and_b32 v245, s50, v50
    v_lshlrev_b32 v246, 16, v51
    v_and_b32 v247, s50, v51
    v_pk_add_f32 v[56:57], v[56:57], v[240:241]
    v_pk_fma_f32 v[60:61], v[240:241], v[240:241], v[60:61]
    v_pk_add_f32 v[58:59], v[58:59], v[242:243]
    v_pk_fma_f32 v[62:63], v[242:243], v[242:243], v[62:63]
    v_pk_add_f32 v[56:57], v[56:57], v[244:245]
    v_pk_fma_f32 v[60:61], v[244:245], v[244:245], v[60:61]
    v_pk_add_f32 v[58:59], v[58:59], v[246:247]
    v_pk_fma_f32 v[62:63], v[246:247], v[246:247], v[62:63]
    s_waitcnt vmcnt(1)
    v_lshlrev_b32 v208, 16, v32
    v_and_b32 v209, s50, v32
    v_lshlrev_b32 v210, 16, v33
    v_and_b32 v211, s50, v33
    v_lshlrev_b32 v212, 16, v34
    v_and_b32 v213, s50, v34
    v_lshlrev_b32 v214, 16, v35
    v_and_b32 v215, s50, v35
    v_pk_add_f32 v[56:57], v[56:57], v[208:209]
    v_pk_fma_f32 v[60:61], v[208:209], v[208:209], v[60:61]
    v_pk_add_f32 v[58:59], v[58:59], v[210:211]
    v_pk_fma_f32 v[62:63], v[210:211], v[210:211], v[62:63]
    v_pk_add_f32 v[56:57], v[56:57], v[212:213]
    v_pk_fma_f32 v[60:61], v[212:213], v[212:213], v[60:61]
    v_pk_add_f32 v[58:59], v[58:59], v[214:215]
    v_pk_fma_f32 v[62:63], v[214:215], v[214:215], v[62:63]
    s_waitcnt vmcnt(0)
    v_lshlrev_b32 v248, 16, v52
    v_and_b32 v249, s50, v52
    v_lshlrev_b32 v250, 16, v53
    v_and_b32 v251, s50, v53
    v_lshlrev_b32 v252, 16, v54
    v_and_b32 v253, s50, v54
    v_lshlrev_b32 v254, 16, v55
    v_and_b32 v255, s50, v55
    v_pk_add_f32 v[56:57], v[56:57], v[248:249]
    v_pk_fma_f32 v[60:61], v[248:249], v[248:249], v[60:61]
    v_pk_add_f32 v[58:59], v[58:59], v[250:251]
    v_pk_fma_f32 v[62:63], v[250:251], v[250:251], v[62:63]
    v_pk_add_f32 v[56:57], v[56:57], v[252:253]
    v_pk_fma_f32 v[60:61], v[252:253], v[252:253], v[60:61]
    v_pk_add_f32 v[58:59], v[58:59], v[254:255]
    v_pk_fma_f32 v[62:63], v[254:255], v[254:255], v[62:63]
    s_branch L_wx
L_loader0:
    v_bfe_u32 v7, v5, 1, 2
    v_lshlrev_b32 v7, 1, v7
    v_xor_b32 v7, v7, v6
    v_mul_u32_u24 v2, 640, v5
    v_lshl_add_u32 v2, v7, 4, v2
    v_add_u32 v2, 143360, v2
    s_mov_b32 s50, 0xffff0000
    s_mov_b32 s30, 50331648
    s_mov_b32 s31, 0x20000
    s_mov_b32 s10, 2211840
    s_mov_b32 s11, 0x20000
    s_mov_b32 s14, 2211840
    s_mov_b32 s15, 0x20000
    s_mov_b32 s34, 2621440
    s_mov_b32 s35, 0x20000
    v_add_u32 v56, 0, v1
    v_mul_u32_u24 v57, 6554, v56
    v_lshrrev_b32 v57, 16, v57
    v_mul_u32_u24 v58, 10, v57
    v_sub_u32 v56, v56, v58
    v_bfe_u32 v58, v57, 2, 2
    v_lshlrev_b32 v58, 3, v58
    v_and_or_b32 v58, v57, 3, v58
    v_lshrrev_b32 v57, 4, v57
    v_lshl_add_u32 v58, v57, 2, v58
    v_mul_u32_u24 v58, 1280, v58
    v_lshl_add_u32 v152, v56, 4, v58
    v_add_u32 v56, 64, v1
    v_mul_u32_u24 v57, 6554, v56
    v_lshrrev_b32 v57, 16, v57
    v_mul_u32_u24 v58, 10, v57
    v_sub_u32 v56, v56, v58
    v_bfe_u32 v58, v57, 2, 2
    v_lshlrev_b32 v58, 3, v58
    v_and_or_b32 v58, v57, 3, v58
    v_lshrrev_b32 v57, 4, v57
    v_lshl_add_u32 v58, v57, 2, v58
    v_mul_u32_u24 v58, 1280, v58
    v_lshl_add_u32 v153, v56, 4, v58
    v_add_u32 v56, 128, v1
    v_mul_u32_u24 v57, 6554, v56
    v_lshrrev_b32 v57, 16, v57
    v_mul_u32_u24 v58, 10, v57
    v_sub_u32 v56, v56, v58
    v_bfe_u32 v58, v57, 2, 2
    v_lshlrev_b32 v58, 3, v58
    v_and_or_b32 v58, v57, 3, v58
    v_lshrrev_b32 v57, 4, v57
    v_lshl_add_u32 v58, v57, 2, v58
    v_mul_u32_u24 v58, 1280, v58
    v_lshl_add_u32 v154, v56, 4, v58
    v_add_u32 v56, 192, v1
    v_mul_u32_u24 v57, 6554, v56
    v_lshrrev_b32 v57, 16, v57
    v_mul_u32_u24 v58, 10, v57
    v_sub_u32 v56, v56, v58
    v_bfe_u32 v58, v57, 2, 2
    v_lshlrev_b32 v58, 3, v58
    v_and_or_b32 v58, v57, 3, v58
    v_lshrrev_b32 v57, 4, v57
    v_lshl_add_u32 v58, v57, 2, v58
    v_mul_u32_u24 v58, 1280, v58
    v_lshl_add_u32 v155, v56, 4, v58
    v_add_u32 v56, 256, v1
    v_mul_u32_u24 v57, 6554, v56
    v_lshrrev_b32 v57, 16, v57
    v_mul_u32_u24 v58, 10, v57
    v_sub_u32 v56, v56, v58
    v_bfe_u32 v58, v57, 2, 2
    v_lshlrev_b32 v58, 3, v58
    v_and_or_b32 v58, v57, 3, v58
    v_lshrrev_b32 v57, 4, v57
    v_lshl_add_u32 v58, v57, 2, v58
    v_mul_u32_u24 v58, 1280, v58
    v_lshl_add_u32 v156, v56, 4, v58
    s_lshr_b32 s45, s2, 2
    s_and_b32 s44, s45, 0x38
    s_and_b32 s47, s2, 7
    s_add_u32 s44, s44, s47
    s_and_b32 s45, s45, 6
    s_mul_i32 s48, s44, 40960
    s_mul_i32 s49, s45, 160
    s_add_u32 s48, s48, s49
    s_add_u32 s49, s48, 160
    buffer_load_dword v136, v144, s[8:11], s54 offen
    buffer_load_dword v137, v145, s[8:11], s54 offen
    buffer_load_dword v138, v146, s[8:11], s54 offen
    buffer_load_dword v139, v147, s[8:11], s54 offen
    buffer_load_dword v140, v148, s[8:11], s54 offen
    s_mov_b32 m0, 129024
    s_nop 0
    buffer_load_dwordx4 v152, s[12:15], s48 offen lds
    s_mov_b32 m0, 130048
    s_nop 0
    buffer_load_dwordx4 v153, s[12:15], s48 offen lds
    s_mov_b32 m0, 131072
    s_nop 0
    buffer_load_dwordx4 v154, s[12:15], s48 offen lds
    s_mov_b32 m0, 132096
    s_nop 0
    buffer_load_dwordx4 v155, s[12:15], s48 offen lds
    s_mov_b32 m0, 133120
    s_nop 0
    buffer_load_dwordx4 v156, s[12:15], s48 offen lds
    s_mov_b32 m0, 134144
    s_nop 0
    buffer_load_dwordx4 v152, s[12:15], s49 offen lds
    s_mov_b32 m0, 135168
    s_nop 0
    buffer_load_dwordx4 v153, s[12:15], s49 offen lds
    s_mov_b32 m0, 136192
    s_nop 0
    buffer_load_dwordx4 v154, s[12:15], s49 offen lds
    s_mov_b32 m0, 137216
    s_nop 0
    buffer_load_dwordx4 v155, s[12:15], s49 offen lds
    s_mov_b32 m0, 138240
    s_nop 0
    buffer_load_dwordx4 v156, s[12:15], s49 offen lds
    v_mov_b32 v56, 139264
    v_mov_b32 v57, 0
    ds_write_b32 v56, v57
    s_waitcnt vmcnt(24)
    v_lshlrev_b32 v176, 16, v16
    v_and_b32 v177, s50, v16
    v_lshlrev_b32 v178, 16, v17
    v_and_b32 v179, s50, v17
    v_lshlrev_b32 v180, 16, v18
    v_and_b32 v181, s50, v18
    v_lshlrev_b32 v182, 16, v19
    v_and_b32 v183, s50, v19
    v_pk_mul_f32 v[60:61], v[176:177], v[176:177]
    v_pk_mul_f32 v[62:63], v[178:179], v[178:179]
    v_pk_add_f32 v[56:57], v[176:177], v[180:181]
    v_pk_fma_f32 v[60:61], v[180:181], v[180:181], v[60:61]
    v_pk_add_f32 v[58:59], v[178:179], v[182:183]
    v_pk_fma_f32 v[62:63], v[182:183], v[182:183], v[62:63]
    s_waitcnt vmcnt(23)
    v_lshlrev_b32 v216, 16, v36
    v_and_b32 v217, s50, v36
    v_lshlrev_b32 v218, 16, v37
    v_and_b32 v219, s50, v37
    v_lshlrev_b32 v220, 16, v38
    v_and_b32 v221, s50, v38
    v_lshlrev_b32 v222, 16, v39
    v_and_b32 v223, s50, v39
    v_pk_add_f32 v[56:57], v[56:57], v[216:217]
    v_pk_fma_f32 v[60:61], v[216:217], v[216:217], v[60:61]
    v_pk_add_f32 v[58:59], v[58:59], v[218:219]
    v_pk_fma_f32 v[62:63], v[218:219], v[218:219], v[62:63]
    v_pk_add_f32 v[56:57], v[56:57], v[220:221]
    v_pk_fma_f32 v[60:61], v[220:221], v[220:221], v[60:61]
    v_pk_add_f32 v[58:59], v[58:59], v[222:223]
    v_pk_fma_f32 v[62:63], v[222:223], v[222:223], v[62:63]
    s_waitcnt vmcnt(22)
    v_lshlrev_b32 v184, 16, v20
    v_and_b32 v185, s50, v20
    v_lshlrev_b32 v186, 16, v21
    v_and_b32 v187, s50, v21
    v_lshlrev_b32 v188, 16, v22
    v_and_b32 v189, s50, v22
    v_lshlrev_b32 v190, 16, v23
    v_and_b32 v191, s50, v23
    v_pk_add_f32 v[56:57], v[56:57], v[184:185]
    v_pk_fma_f32 v[60:61], v[184:185], v[184:185], v[60:61]
    v_pk_add_f32 v[58:59], v[58:59], v[186:187]
    v_pk_fma_f32 v[62:63], v[186:187], v[186:187], v[62:63]
    v_pk_add_f32 v[56:57], v[56:57], v[188:189]
    v_pk_fma_f32 v[60:61], v[188:189], v[188:189], v[60:61]
    v_pk_add_f32 v[58:59], v[58:59], v[190:191]
    v_pk_fma_f32 v[62:63], v[190:191], v[190:191], v[62:63]
    s_waitcnt vmcnt(21)
    v_lshlrev_b32 v224, 16, v40
    v_and_b32 v225, s50, v40
    v_lshlrev_b32 v226, 16, v41
    v_and_b32 v227, s50, v41
    v_lshlrev_b32 v228, 16, v42
    v_and_b32 v229, s50, v42
    v_lshlrev_b32 v230, 16, v43
    v_and_b32 v231, s50, v43
    v_pk_add_f32 v[56:57], v[56:57], v[224:225]
    v_pk_fma_f32 v[60:61], v[224:225], v[224:225], v[60:61]
    v_pk_add_f32 v[58:59], v[58:59], v[226:227]
    v_pk_fma_f32 v[62:63], v[226:227], v[226:227], v[62:63]
    v_pk_add_f32 v[56:57], v[56:57], v[228:229]
    v_pk_fma_f32 v[60:61], v[228:229], v[228:229], v[60:61]
    v_pk_add_f32 v[58:59], v[58:59], v[230:231]
    v_pk_fma_f32 v[62:63], v[230:231], v[230:231], v[62:63]
    s_waitcnt vmcnt(20)
    v_lshlrev_b32 v192, 16, v24
    v_and_b32 v193, s50, v24
    v_lshlrev_b32 v194, 16, v25
    v_and_b32 v195, s50, v25
    v_lshlrev_b32 v196, 16, v26
    v_and_b32 v197, s50, v26
    v_lshlrev_b32 v198, 16, v27
    v_and_b32 v199, s50, v27
    v_pk_add_f32 v[56:57], v[56:57], v[192:193]
    v_pk_fma_f32 v[60:61], v[192:193], v[192:193], v[60:61]
    v_pk_add_f32 v[58:59], v[58:59], v[194:195]
    v_pk_fma_f32 v[62:63], v[194:195], v[194:195], v[62:63]
    v_pk_add_f32 v[56:57], v[56:57], v[196:197]
    v_pk_fma_f32 v[60:61], v[196:197], v[196:197], v[60:61]
    v_pk_add_f32 v[58:59], v[58:59], v[198:199]
    v_pk_fma_f32 v[62:63], v[198:199], v[198:199], v[62:63]
    s_waitcnt vmcnt(19)
    v_lshlrev_b32 v232, 16, v44
    v_and_b32 v233, s50, v44
    v_lshlrev_b32 v234, 16, v45
    v_and_b32 v235, s50, v45
    v_lshlrev_b32 v236, 16, v46
    v_and_b32 v237, s50, v46
    v_lshlrev_b32 v238, 16, v47
    v_and_b32 v239, s50, v47
    v_pk_add_f32 v[56:57], v[56:57], v[232:233]
    v_pk_fma_f32 v[60:61], v[232:233], v[232:233], v[60:61]
    v_pk_add_f32 v[58:59], v[58:59], v[234:235]
    v_pk_fma_f32 v[62:63], v[234:235], v[234:235], v[62:63]
    v_pk_add_f32 v[56:57], v[56:57], v[236:237]
    v_pk_fma_f32 v[60:61], v[236:237], v[236:237], v[60:61]
    v_pk_add_f32 v[58:59], v[58:59], v[238:239]
    v_pk_fma_f32 v[62:63], v[238:239], v[238:239], v[62:63]
    s_waitcnt vmcnt(18)
    v_lshlrev_b32 v200, 16, v28
    v_and_b32 v201, s50, v28
    v_lshlrev_b32 v202, 16, v29
    v_and_b32 v203, s50, v29
    v_lshlrev_b32 v204, 16, v30
    v_and_b32 v205, s50, v30
    v_lshlrev_b32 v206, 16, v31
    v_and_b32 v207, s50, v31
    v_pk_add_f32 v[56:57], v[56:57], v[200:201]
    v_pk_fma_f32 v[60:61], v[200:201], v[200:201], v[60:61]
    v_pk_add_f32 v[58:59], v[58:59], v[202:203]
    v_pk_fma_f32 v[62:63], v[202:203], v[202:203], v[62:63]
    v_pk_add_f32 v[56:57], v[56:57], v[204:205]
    v_pk_fma_f32 v[60:61], v[204:205], v[204:205], v[60:61]
    v_pk_add_f32 v[58:59], v[58:59], v[206:207]
    v_pk_fma_f32 v[62:63], v[206:207], v[206:207], v[62:63]
    s_waitcnt vmcnt(17)
    v_lshlrev_b32 v240, 16, v48
    v_and_b32 v241, s50, v48
    v_lshlrev_b32 v242, 16, v49
    v_and_b32 v243, s50, v49
    v_lshlrev_b32 v244, 16, v50
    v_and_b32 v245, s50, v50
    v_lshlrev_b32 v246, 16, v51
    v_and_b32 v247, s50, v51
    v_pk_add_f32 v[56:57], v[56:57], v[240:241]
    v_pk_fma_f32 v[60:61], v[240:241], v[240:241], v[60:61]
    v_pk_add_f32 v[58:59], v[58:59], v[242:243]
    v_pk_fma_f32 v[62:63], v[242:243], v[242:243], v[62:63]
    v_pk_add_f32 v[56:57], v[56:57], v[244:245]
    v_pk_fma_f32 v[60:61], v[244:245], v[244:245], v[60:61]
    v_pk_add_f32 v[58:59], v[58:59], v[246:247]
    v_pk_fma_f32 v[62:63], v[246:247], v[246:247], v[62:63]
    s_waitcnt vmcnt(16)
    v_lshlrev_b32 v208, 16, v32
    v_and_b32 v209, s50, v32
    v_lshlrev_b32 v210, 16, v33
    v_and_b32 v211, s50, v33
    v_lshlrev_b32 v212, 16, v34
    v_and_b32 v213, s50, v34
    v_lshlrev_b32 v214, 16, v35
    v_and_b32 v215, s50, v35
    v_pk_add_f32 v[56:57], v[56:57], v[208:209]
    v_pk_fma_f32 v[60:61], v[208:209], v[208:209], v[60:61]
    v_pk_add_f32 v[58:59], v[58:59], v[210:211]
    v_pk_fma_f32 v[62:63], v[210:211], v[210:211], v[62:63]
    v_pk_add_f32 v[56:57], v[56:57], v[212:213]
    v_pk_fma_f32 v[60:61], v[212:213], v[212:213], v[60:61]
    v_pk_add_f32 v[58:59], v[58:59], v[214:215]
    v_pk_fma_f32 v[62:63], v[214:215], v[214:215], v[62:63]
    s_waitcnt vmcnt(15)
    v_lshlrev_b32 v248, 16, v52
    v_and_b32 v249, s50, v52
    v_lshlrev_b32 v250, 16, v53
    v_and_b32 v251, s50, v53
    v_lshlrev_b32 v252, 16, v54
    v_and_b32 v253, s50, v54
    v_lshlrev_b32 v254, 16, v55
    v_and_b32 v255, s50, v55
    v_pk_add_f32 v[56:57], v[56:57], v[248:249]
    v_pk_fma_f32 v[60:61], v[248:249], v[248:249], v[60:61]
    v_pk_add_f32 v[58:59], v[58:59], v[250:251]
    v_pk_fma_f32 v[62:63], v[250:251], v[250:251], v[62:63]
    v_pk_add_f32 v[56:57], v[56:57], v[252:253]
    v_pk_fma_f32 v[60:61], v[252:253], v[252:253], v[60:61]
    v_pk_add_f32 v[58:59], v[58:59], v[254:255]
    v_pk_fma_f32 v[62:63], v[254:255], v[254:255], v[62:63]
L_wx:
    v_pk_add_f32 v[56:57], v[56:57], v[58:59]
    v_pk_add_f32 v[60:61], v[60:61], v[62:63]
    v_add_f32 v56, v56, v57
    v_add_f32 v57, v60, v61
    s_nop 0
    v_add_f32_dpp v56, v56, v56 quad_perm:[1,0,3,2] row_mask:0xf bank_mask:0xf
    v_add_f32_dpp v57, v57, v57 quad_perm:[1,0,3,2] row_mask:0xf bank_mask:0xf
    s_nop 0
    v_add_f32_dpp v56, v56, v56 quad_perm:[2,3,0,1] row_mask:0xf bank_mask:0xf
    v_add_f32_dpp v57, v57, v57 quad_perm:[2,3,0,1] row_mask:0xf bank_mask:0xf
    s_nop 0
    v_add_f32_dpp v56, v56, v56 row_half_mirror row_mask:0xf bank_mask:0xf
    v_add_f32_dpp v57, v57, v57 row_half_mirror row_mask:0xf bank_mask:0xf
    s_mov_b32 s50, 0x3acccccd
    s_cmp_eq_u32 s37, 0
    s_cselect_b32 s51, 1.0, -1.0
    s_cselect_b32 s55, -2.0, 0
    v_mul_f32 v56, s50, v56
    v_mul_f32 v57, s50, v57
    v_fma_f32 v57, -v56, v56, v57
    v_max_f32 v57, 0, v57
    v_add_f32 v57, 0x3727c5ac, v57
    v_rsq_f32 v58, v57
    v_mul_f32 v56, s55, v56
    v_mul_f32 v60, s51, v58
    v_mul_f32 v62, v56, v58
    v_pk_fma_f32 v[216:217], v[216:217], v[60:61], v[62:63] op_sel_hi:[1,0,0]
    v_pk_fma_f32 v[218:219], v[218:219], v[60:61], v[62:63] op_sel_hi:[1,0,0]
    v_pk_fma_f32 v[220:221], v[220:221], v[60:61], v[62:63] op_sel_hi:[1,0,0]
    v_pk_fma_f32 v[222:223], v[222:223], v[60:61], v[62:63] op_sel_hi:[1,0,0]
    v_pk_fma_f32 v[176:177], v[176:177], v[58:59], v[216:217] op_sel_hi:[1,0,1]
    v_pk_fma_f32 v[178:179], v[178:179], v[58:59], v[218:219] op_sel_hi:[1,0,1]
    v_pk_fma_f32 v[180:181], v[180:181], v[58:59], v[220:221] op_sel_hi:[1,0,1]
    v_pk_fma_f32 v[182:183], v[182:183], v[58:59], v[222:223] op_sel_hi:[1,0,1]
    v_cvt_pk_bf16_f32 v16, v176, v177
    v_cvt_pk_bf16_f32 v17, v178, v179
    v_cvt_pk_bf16_f32 v18, v180, v181
    v_cvt_pk_bf16_f32 v19, v182, v183
    ds_write_b128 v2, v[16:19] offset:0
    v_pk_fma_f32 v[224:225], v[224:225], v[60:61], v[62:63] op_sel_hi:[1,0,0]
    v_pk_fma_f32 v[226:227], v[226:227], v[60:61], v[62:63] op_sel_hi:[1,0,0]
    v_pk_fma_f32 v[228:229], v[228:229], v[60:61], v[62:63] op_sel_hi:[1,0,0]
    v_pk_fma_f32 v[230:231], v[230:231], v[60:61], v[62:63] op_sel_hi:[1,0,0]
    v_pk_fma_f32 v[184:185], v[184:185], v[58:59], v[224:225] op_sel_hi:[1,0,1]
    v_pk_fma_f32 v[186:187], v[186:187], v[58:59], v[226:227] op_sel_hi:[1,0,1]
    v_pk_fma_f32 v[188:189], v[188:189], v[58:59], v[228:229] op_sel_hi:[1,0,1]
    v_pk_fma_f32 v[190:191], v[190:191], v[58:59], v[230:231] op_sel_hi:[1,0,1]
    v_cvt_pk_bf16_f32 v20, v184, v185
    v_cvt_pk_bf16_f32 v21, v186, v187
    v_cvt_pk_bf16_f32 v22, v188, v189
    v_cvt_pk_bf16_f32 v23, v190, v191
    ds_write_b128 v2, v[20:23] offset:128
    v_pk_fma_f32 v[232:233], v[232:233], v[60:61], v[62:63] op_sel_hi:[1,0,0]
    v_pk_fma_f32 v[234:235], v[234:235], v[60:61], v[62:63] op_sel_hi:[1,0,0]
    v_pk_fma_f32 v[236:237], v[236:237], v[60:61], v[62:63] op_sel_hi:[1,0,0]
    v_pk_fma_f32 v[238:239], v[238:239], v[60:61], v[62:63] op_sel_hi:[1,0,0]
    v_pk_fma_f32 v[192:193], v[192:193], v[58:59], v[232:233] op_sel_hi:[1,0,1]
    v_pk_fma_f32 v[194:195], v[194:195], v[58:59], v[234:235] op_sel_hi:[1,0,1]
    v_pk_fma_f32 v[196:197], v[196:197], v[58:59], v[236:237] op_sel_hi:[1,0,1]
    v_pk_fma_f32 v[198:199], v[198:199], v[58:59], v[238:239] op_sel_hi:[1,0,1]
    v_cvt_pk_bf16_f32 v24, v192, v193
    v_cvt_pk_bf16_f32 v25, v194, v195
    v_cvt_pk_bf16_f32 v26, v196, v197
    v_cvt_pk_bf16_f32 v27, v198, v199
    ds_write_b128 v2, v[24:27] offset:256
    v_pk_fma_f32 v[240:241], v[240:241], v[60:61], v[62:63] op_sel_hi:[1,0,0]
    v_pk_fma_f32 v[242:243], v[242:243], v[60:61], v[62:63] op_sel_hi:[1,0,0]
    v_pk_fma_f32 v[244:245], v[244:245], v[60:61], v[62:63] op_sel_hi:[1,0,0]
    v_pk_fma_f32 v[246:247], v[246:247], v[60:61], v[62:63] op_sel_hi:[1,0,0]
    v_pk_fma_f32 v[200:201], v[200:201], v[58:59], v[240:241] op_sel_hi:[1,0,1]
    v_pk_fma_f32 v[202:203], v[202:203], v[58:59], v[242:243] op_sel_hi:[1,0,1]
    v_pk_fma_f32 v[204:205], v[204:205], v[58:59], v[244:245] op_sel_hi:[1,0,1]
    v_pk_fma_f32 v[206:207], v[206:207], v[58:59], v[246:247] op_sel_hi:[1,0,1]
    v_cvt_pk_bf16_f32 v28, v200, v201
    v_cvt_pk_bf16_f32 v29, v202, v203
    v_cvt_pk_bf16_f32 v30, v204, v205
    v_cvt_pk_bf16_f32 v31, v206, v207
    ds_write_b128 v2, v[28:31] offset:384
    v_pk_fma_f32 v[248:249], v[248:249], v[60:61], v[62:63] op_sel_hi:[1,0,0]
    v_pk_fma_f32 v[250:251], v[250:251], v[60:61], v[62:63] op_sel_hi:[1,0,0]
    v_pk_fma_f32 v[252:253], v[252:253], v[60:61], v[62:63] op_sel_hi:[1,0,0]
    v_pk_fma_f32 v[254:255], v[254:255], v[60:61], v[62:63] op_sel_hi:[1,0,0]
    v_pk_fma_f32 v[208:209], v[208:209], v[58:59], v[248:249] op_sel_hi:[1,0,1]
    v_pk_fma_f32 v[210:211], v[210:211], v[58:59], v[250:251] op_sel_hi:[1,0,1]
    v_pk_fma_f32 v[212:213], v[212:213], v[58:59], v[252:253] op_sel_hi:[1,0,1]
    v_pk_fma_f32 v[214:215], v[214:215], v[58:59], v[254:255] op_sel_hi:[1,0,1]
    v_cvt_pk_bf16_f32 v32, v208, v209
    v_cvt_pk_bf16_f32 v33, v210, v211
    v_cvt_pk_bf16_f32 v34, v212, v213
    v_cvt_pk_bf16_f32 v35, v214, v215
    ds_write_b128 v2, v[32:35] offset:512
    s_mov_b32 s50, 0x80000000
    s_mov_b32 s51, 0x80008000
    s_waitcnt lgkmcnt(0)
    s_add_u32 s24, s24, 1
    s_barrier
    s_cmp_eq_u32 s68, 1
    s_cbranch_scc1 L_loader1
    s_cmp_eq_u32 s3, 2
    s_cbranch_scc1 L_s1one
    ds_read_b128 v[16:19], v7 offset:0
    ds_read_b128 v[20:23], v7 offset:10240
    ds_read_b128 v[24:27], v8 offset:0
    ds_read_b128 v[28:31], v8 offset:10240
    s_lshl_b32 s36, s41, 1
    s_add_u32 s36, s36, s37
    s_lshl_b32 s36, s36, 6
    s_add_u32 s36, s36, s40
    s_add_u32 s38, s36, 1310720
    s_lshl_b32 s39, s43, 1
    s_add_u32 s39, s39, s37
    s_lshl_b32 s39, s39, 6
    s_add_u32 s39, s39, s40
    s_add_u32 s43, s39, 1310720
    s_sub_u32 s46, 1, s37
    s_lshl_b32 s45, s3, 12
    s_add_u32 s45, s45, 126976
    v_cvt_f32_u32 v87, s46
    v_cvt_f32_u32 v88, s37
    v_mul_u32_u24 v10, 81920, v3
    v_lshl_add_u32 v10, v4, 4, v10
    v_mul_f32 v80, v87, v90
    v_mul_f32 v81, v88, v90
    v_mul_f32 v82, v87, v91
    v_mul_f32 v83, v88, v91
    v_lshlrev_b32 v216, 2, v4
    v_cvt_f32_u32 v217, v3
    ds_read_b128 v[32:35], v7 offset:128
    ds_read_b128 v[36:39], v7 offset:10368
    s_waitcnt lgkmcnt(4)
    v_mfma_f32_16x16x32_bf16 v[40:43], v[16:19], v[96:99], 0
    v_cvt_f32_u32 v216, v216
    v_mul_f32 v217, 0xbd000000, v217
    v_mfma_f32_16x16x32_bf16 v[44:47], v[20:23], v[96:99], 0
    v_and_b32 v230, 1, v3
    v_mul_f32 v218, v216, v217
    v_mfma_f32_16x16x32_bf16 v[48:51], v[16:19], v[116:119], 0
    v_mul_u32_u24 v230, 0x8000, v230
    v_add_f32 v219, v218, v217
    v_mfma_f32_16x16x32_bf16 v[52:55], v[20:23], v[116:119], 0
    ds_read_b128 v[16:19], v8 offset:128
    ds_read_b128 v[20:23], v8 offset:10368
    s_waitcnt lgkmcnt(4)
    v_mfma_f32_16x16x32_bf16 v[40:43], v[24:27], v[100:103], v[40:43]
    v_cos_f32 v222, v218
    v_add_f32 v220, v219, v217
    v_mfma_f32_16x16x32_bf16 v[44:47], v[28:31], v[100:103], v[44:47]
    v_sin_f32 v226, v218
    v_add_f32 v221, v220, v217
    v_mfma_f32_16x16x32_bf16 v[48:51], v[24:27], v[120:123], v[48:51]
    v_cos_f32 v223, v219
    v_lshl_or_b32 v230, v230, 16, v230
    v_mfma_f32_16x16x32_bf16 v[52:55], v[28:31], v[120:123], v[52:55]
    ds_read_b128 v[24:27], v7 offset:256
    ds_read_b128 v[28:31], v7 offset:10496
    s_waitcnt lgkmcnt(4)
    v_mfma_f32_16x16x32_bf16 v[40:43], v[32:35], v[104:107], v[40:43]
    v_sin_f32 v227, v219
    v_cos_f32 v224, v220
    v_mfma_f32_16x16x32_bf16 v[44:47], v[36:39], v[104:107], v[44:47]
    v_sin_f32 v228, v220
    v_cvt_pk_bf16_f32 v72, v222, v223
    v_mfma_f32_16x16x32_bf16 v[48:51], v[32:35], v[124:127], v[48:51]
    v_cos_f32 v225, v221
    v_cvt_pk_bf16_f32 v76, v226, v227
    v_mfma_f32_16x16x32_bf16 v[52:55], v[36:39], v[124:127], v[52:55]
    ds_read_b128 v[32:35], v8 offset:256
    ds_read_b128 v[36:39], v8 offset:10496
    s_waitcnt lgkmcnt(4)
    v_mfma_f32_16x16x32_bf16 v[40:43], v[16:19], v[108:111], v[40:43]
    v_sin_f32 v229, v221
    v_xor_b32 v74, v230, v72
    v_mfma_f32_16x16x32_bf16 v[44:47], v[20:23], v[108:111], v[44:47]
    v_cvt_pk_bf16_f32 v73, v224, v225
    v_cvt_pk_bf16_f32 v77, v228, v229
    v_mfma_f32_16x16x32_bf16 v[48:51], v[16:19], v[128:131], v[48:51]
    v_xor_b32 v78, v230, v76
    v_xor_b32 v75, v230, v73
    v_mfma_f32_16x16x32_bf16 v[52:55], v[20:23], v[128:131], v[52:55]
    ds_read_b128 v[16:19], v7 offset:384
    ds_read_b128 v[20:23], v7 offset:10624
    s_waitcnt lgkmcnt(4)
    v_mfma_f32_16x16x32_bf16 v[40:43], v[24:27], v[112:115], v[40:43]
    v_xor_b32 v79, v230, v77
    v_xor_b32 v208, s50, v72
    v_mfma_f32_16x16x32_bf16 v[44:47], v[28:31], v[112:115], v[44:47]
    v_xor_b32 v209, s50, v73
    v_xor_b32 v210, s50, v74
    v_mfma_f32_16x16x32_bf16 v[48:51], v[24:27], v[132:135], v[48:51]
    v_xor_b32 v211, s50, v75
    v_xor_b32 v212, s50, v76
    v_mfma_f32_16x16x32_bf16 v[52:55], v[28:31], v[132:135], v[52:55]
    ds_read_b128 v[24:27], v8 offset:384
    ds_read_b128 v[28:31], v8 offset:10624
    s_waitcnt lgkmcnt(4)
    v_mfma_f32_16x16x32_bf16 v[56:59], v[32:35], v[96:99], 0
    v_xor_b32 v213, s50, v77
    v_xor_b32 v214, s50, v78
    v_mfma_f32_16x16x32_bf16 v[60:63], v[36:39], v[96:99], 0
    v_xor_b32 v215, s50, v79
    v_mfma_f32_16x16x32_bf16 v[64:67], v[32:35], v[116:119], 0
    v_mfma_f32_16x16x32_bf16 v[68:71], v[36:39], v[116:119], 0
    ds_read_b128 v[32:35], v7 offset:512
    ds_read_b128 v[36:39], v7 offset:10752
    s_waitcnt lgkmcnt(4)
    v_mfma_f32_16x16x32_bf16 v[56:59], v[16:19], v[100:103], v[56:59]
    v_mfma_f32_16x16x32_bf16 v[60:63], v[20:23], v[100:103], v[60:63]
    v_mfma_f32_16x16x32_bf16 v[64:67], v[16:19], v[120:123], v[64:67]
    v_mfma_f32_16x16x32_bf16 v[68:71], v[20:23], v[120:123], v[68:71]
    ds_read_b128 v[16:19], v8 offset:512
    ds_read_b128 v[20:23], v8 offset:10752
    s_waitcnt lgkmcnt(4)
    v_mfma_f32_16x16x32_bf16 v[56:59], v[24:27], v[104:107], v[56:59]
    v_mfma_f32_16x16x32_bf16 v[60:63], v[28:31], v[104:107], v[60:63]
    v_mfma_f32_16x16x32_bf16 v[64:67], v[24:27], v[124:127], v[64:67]
    v_mfma_f32_16x16x32_bf16 v[68:71], v[28:31], v[124:127], v[68:71]
    ds_read_b128 v[24:27], v7 offset:0
    ds_read_b128 v[28:31], v7 offset:10240
    s_waitcnt lgkmcnt(4)
    v_mfma_f32_16x16x32_bf16 v[56:59], v[32:35], v[108:111], v[56:59]
    v_mfma_f32_16x16x32_bf16 v[60:63], v[36:39], v[108:111], v[60:63]
    v_mfma_f32_16x16x32_bf16 v[64:67], v[32:35], v[128:131], v[64:67]
    v_mfma_f32_16x16x32_bf16 v[68:71], v[36:39], v[128:131], v[68:71]
    ds_read_b128 v[32:35], v8 offset:0
    ds_read_b128 v[36:39], v8 offset:10240
    s_waitcnt lgkmcnt(4)
    v_mfma_f32_16x16x32_bf16 v[56:59], v[16:19], v[112:115], v[56:59]
    v_mfma_f32_16x16x32_bf16 v[60:63], v[20:23], v[112:115], v[60:63]
    v_mfma_f32_16x16x32_bf16 v[64:67], v[16:19], v[132:135], v[64:67]
    v_mfma_f32_16x16x32_bf16 v[68:71], v[20:23], v[132:135], v[68:71]
    ds_read_b128 v[16:19], v7 offset:128
    ds_read_b128 v[20:23], v7 offset:10368
    s_waitcnt lgkmcnt(4)
    v_mfma_f32_16x16x32_bf16 v[176:179], v[24:27], v[136:139], 0
    v_mfma_f32_16x16x32_bf16 v[180:183], v[28:31], v[136:139], 0
    v_mfma_f32_16x16x32_bf16 v[184:187], v[24:27], v[156:159], 0
    v_mfma_f32_16x16x32_bf16 v[188:191], v[28:31], v[156:159], 0
    ds_read_b128 v[24:27], v8 offset:128
    ds_read_b128 v[28:31], v8 offset:10368
    s_waitcnt lgkmcnt(4)
    v_mfma_f32_16x16x32_bf16 v[176:179], v[32:35], v[140:143], v[176:179]
    v_fmac_f32 v40, v56, v80
    v_fmac_f32 v48, v64, v80
    v_mfma_f32_16x16x32_bf16 v[180:183], v[36:39], v[140:143], v[180:183]
    v_fmac_f32 v41, v57, v80
    v_fmac_f32 v49, v65, v80
    v_mfma_f32_16x16x32_bf16 v[184:187], v[32:35], v[160:163], v[184:187]
    v_fmac_f32 v42, v58, v80
    v_fmac_f32 v50, v66, v80
    v_mfma_f32_16x16x32_bf16 v[188:191], v[36:39], v[160:163], v[188:191]
    ds_read_b128 v[32:35], v7 offset:256
    ds_read_b128 v[36:39], v7 offset:10496
    s_waitcnt lgkmcnt(4)
    v_mfma_f32_16x16x32_bf16 v[176:179], v[16:19], v[144:147], v[176:179]
    v_fmac_f32 v43, v59, v80
    v_fmac_f32 v51, v67, v80
    v_mfma_f32_16x16x32_bf16 v[180:183], v[20:23], v[144:147], v[180:183]
    v_fmac_f32 v44, v60, v80
    v_fmac_f32 v52, v68, v80
    v_mfma_f32_16x16x32_bf16 v[184:187], v[16:19], v[164:167], v[184:187]
    v_fmac_f32 v45, v61, v80
    v_fmac_f32 v53, v69, v80
    v_mfma_f32_16x16x32_bf16 v[188:191], v[20:23], v[164:167], v[188:191]
    ds_read_b128 v[16:19], v8 offset:256
    ds_read_b128 v[20:23], v8 offset:10496
    s_waitcnt lgkmcnt(4)
    v_mfma_f32_16x16x32_bf16 v[176:179], v[24:27], v[148:151], v[176:179]
    v_fmac_f32 v46, v62, v80
    v_fmac_f32 v54, v70, v80
    v_mfma_f32_16x16x32_bf16 v[180:183], v[28:31], v[148:151], v[180:183]
    v_fmac_f32 v47, v63, v80
    v_fmac_f32 v55, v71, v80
    v_mfma_f32_16x16x32_bf16 v[184:187], v[24:27], v[168:171], v[184:187]
    v_fmac_f32 v40, v64, v81
    v_fma_f32 v48, -v56, v81, v48
    v_mfma_f32_16x16x32_bf16 v[188:191], v[28:31], v[168:171], v[188:191]
    ds_read_b128 v[24:27], v7 offset:384
    ds_read_b128 v[28:31], v7 offset:10624
    s_waitcnt lgkmcnt(4)
    v_mfma_f32_16x16x32_bf16 v[176:179], v[32:35], v[152:155], v[176:179]
    v_fmac_f32 v41, v65, v81
    v_fma_f32 v49, -v57, v81, v49
    v_mfma_f32_16x16x32_bf16 v[180:183], v[36:39], v[152:155], v[180:183]
    v_fmac_f32 v42, v66, v81
    v_fma_f32 v50, -v58, v81, v50
    v_mfma_f32_16x16x32_bf16 v[184:187], v[32:35], v[172:175], v[184:187]
    v_fmac_f32 v43, v67, v81
    v_fma_f32 v51, -v59, v81, v51
    v_mfma_f32_16x16x32_bf16 v[188:191], v[36:39], v[172:175], v[188:191]
    ds_read_b128 v[32:35], v8 offset:384
    ds_read_b128 v[36:39], v8 offset:10624
    s_waitcnt lgkmcnt(4)
    v_mfma_f32_16x16x32_bf16 v[192:195], v[16:19], v[136:139], 0
    v_fmac_f32 v44, v68, v81
    v_fma_f32 v52, -v60, v81, v52
    v_mfma_f32_16x16x32_bf16 v[196:199], v[20:23], v[136:139], 0
    v_fmac_f32 v45, v69, v81
    v_fma_f32 v53, -v61, v81, v53
    v_mfma_f32_16x16x32_bf16 v[200:203], v[16:19], v[156:159], 0
    v_fmac_f32 v46, v70, v81
    v_fma_f32 v54, -v62, v81, v54
    v_mfma_f32_16x16x32_bf16 v[204:207], v[20:23], v[156:159], 0
    ds_read_b128 v[16:19], v7 offset:512
    ds_read_b128 v[20:23], v7 offset:10752
    s_waitcnt lgkmcnt(4)
    v_mfma_f32_16x16x32_bf16 v[192:195], v[24:27], v[140:143], v[192:195]
    v_fmac_f32 v47, v71, v81
    v_fma_f32 v55, -v63, v81, v55
    v_mfma_f32_16x16x32_bf16 v[196:199], v[28:31], v[140:143], v[196:199]
    v_cvt_pk_bf16_f32 v96, v40, v41
    v_cvt_pk_bf16_f32 v97, v42, v43
    v_mfma_f32_16x16x32_bf16 v[200:203], v[24:27], v[160:163], v[200:203]
    v_cvt_pk_bf16_f32 v98, v44, v45
    v_cvt_pk_bf16_f32 v99, v46, v47
    v_mfma_f32_16x16x32_bf16 v[204:207], v[28:31], v[160:163], v[204:207]
    ds_read_b128 v[24:27], v8 offset:512
    ds_read_b128 v[28:31], v8 offset:10752
    s_waitcnt lgkmcnt(4)
    v_mfma_f32_16x16x32_bf16 v[192:195], v[32:35], v[144:147], v[192:195]
    v_cvt_pk_bf16_f32 v100, v48, v49
    v_cvt_pk_bf16_f32 v101, v50, v51
    v_mfma_f32_16x16x32_bf16 v[196:199], v[36:39], v[144:147], v[196:199]
    v_cvt_pk_bf16_f32 v102, v52, v53
    v_cvt_pk_bf16_f32 v103, v54, v55
    v_mfma_f32_16x16x32_bf16 v[200:203], v[32:35], v[164:167], v[200:203]
    v_xor_b32 v104, s51, v100
    v_xor_b32 v105, s51, v101
    v_mfma_f32_16x16x32_bf16 v[204:207], v[36:39], v[164:167], v[204:207]
    s_waitcnt lgkmcnt(2)
    v_mfma_f32_16x16x32_bf16 v[192:195], v[16:19], v[148:151], v[192:195]
    v_xor_b32 v106, s51, v102
    v_xor_b32 v107, s51, v103
    v_mfma_f32_16x16x32_bf16 v[196:199], v[20:23], v[148:151], v[196:199]
    v_mfma_f32_16x16x32_bf16 v[108:111], v[96:99], v[72:75], 0
    v_mfma_f32_16x16x32_bf16 v[116:119], v[96:99], v[76:79], 0
    v_mfma_f32_16x16x32_bf16 v[200:203], v[16:19], v[168:171], v[200:203]
    v_mfma_f32_16x16x32_bf16 v[112:115], v[96:99], v[208:211], 0
    v_mfma_f32_16x16x32_bf16 v[120:123], v[96:99], v[212:215], 0
    v_mfma_f32_16x16x32_bf16 v[204:207], v[20:23], v[168:171], v[204:207]
    s_waitcnt lgkmcnt(0)
    v_mfma_f32_16x16x32_bf16 v[192:195], v[24:27], v[152:155], v[192:195]
    v_mfma_f32_16x16x32_bf16 v[108:111], v[104:107], v[76:79], v[108:111]
    v_mfma_f32_16x16x32_bf16 v[116:119], v[100:103], v[72:75], v[116:119]
    v_mfma_f32_16x16x32_bf16 v[196:199], v[28:31], v[152:155], v[196:199]
    v_mfma_f32_16x16x32_bf16 v[112:115], v[104:107], v[212:215], v[112:115]
    v_mfma_f32_16x16x32_bf16 v[120:123], v[100:103], v[208:211], v[120:123]
    v_mfma_f32_16x16x32_bf16 v[200:203], v[24:27], v[172:175], v[200:203]
    v_mfma_f32_16x16x32_bf16 v[204:207], v[28:31], v[172:175], v[204:207]
    s_nop 2
    v_cvt_pk_bf16_f32 v124, v108, v116
    v_cvt_pk_bf16_f32 v125, v109, v117
    v_cvt_pk_bf16_f32 v126, v110, v118
    v_cvt_pk_bf16_f32 v127, v111, v119
    buffer_store_dwordx4 v[124:127], v10, s[28:31], s36 offen sc1
    v_cvt_pk_bf16_f32 v128, v112, v120
    v_cvt_pk_bf16_f32 v129, v113, v121
    v_cvt_pk_bf16_f32 v130, v114, v122
    v_cvt_pk_bf16_f32 v131, v115, v123
    buffer_store_dwordx4 v[128:131], v10, s[28:31], s38 offen sc1
    v_pk_fma_f32 v[176:177], v[192:193], v[82:83], v[176:177] op_sel_hi:[1,0,1]
    v_pk_fma_f32 v[184:185], v[200:201], v[82:83], v[184:185] op_sel_hi:[1,0,1]
    v_pk_fma_f32 v[178:179], v[194:195], v[82:83], v[178:179] op_sel_hi:[1,0,1]
    v_pk_fma_f32 v[186:187], v[202:203], v[82:83], v[186:187] op_sel_hi:[1,0,1]
    v_pk_fma_f32 v[180:181], v[196:197], v[82:83], v[180:181] op_sel_hi:[1,0,1]
    v_pk_fma_f32 v[188:189], v[204:205], v[82:83], v[188:189] op_sel_hi:[1,0,1]
    v_pk_fma_f32 v[182:183], v[198:199], v[82:83], v[182:183] op_sel_hi:[1,0,1]
    v_pk_fma_f32 v[190:191], v[206:207], v[82:83], v[190:191] op_sel_hi:[1,0,1]
    v_pk_fma_f32 v[176:177], v[200:201], v[82:83], v[176:177] op_sel:[0,1,0] op_sel_hi:[1,1,1]
    v_pk_fma_f32 v[184:185], v[192:193], v[82:83], v[184:185] op_sel:[0,1,0] op_sel_hi:[1,1,1] neg_lo:[0,1,0] neg_hi:[0,1,0]
    v_pk_fma_f32 v[178:179], v[202:203], v[82:83], v[178:179] op_sel:[0,1,0] op_sel_hi:[1,1,1]
    v_pk_fma_f32 v[186:187], v[194:195], v[82:83], v[186:187] op_sel:[0,1,0] op_sel_hi:[1,1,1] neg_lo:[0,1,0] neg_hi:[0,1,0]
    v_pk_fma_f32 v[180:181], v[204:205], v[82:83], v[180:181] op_sel:[0,1,0] op_sel_hi:[1,1,1]
    v_pk_fma_f32 v[188:189], v[196:197], v[82:83], v[188:189] op_sel:[0,1,0] op_sel_hi:[1,1,1] neg_lo:[0,1,0] neg_hi:[0,1,0]
    v_pk_fma_f32 v[182:183], v[206:207], v[82:83], v[182:183] op_sel:[0,1,0] op_sel_hi:[1,1,1]
    v_pk_fma_f32 v[190:191], v[198:199], v[82:83], v[190:191] op_sel:[0,1,0] op_sel_hi:[1,1,1] neg_lo:[0,1,0] neg_hi:[0,1,0]
    v_cvt_pk_bf16_f32 v136, v176, v177
    v_cvt_pk_bf16_f32 v137, v178, v179
    v_cvt_pk_bf16_f32 v138, v180, v181
    v_cvt_pk_bf16_f32 v139, v182, v183
    v_cvt_pk_bf16_f32 v140, v184, v185
    v_cvt_pk_bf16_f32 v141, v186, v187
    v_cvt_pk_bf16_f32 v142, v188, v189
    v_cvt_pk_bf16_f32 v143, v190, v191
    v_xor_b32 v144, s51, v140
    v_xor_b32 v145, s51, v141
    v_xor_b32 v146, s51, v142
    v_xor_b32 v147, s51, v143
    v_mfma_f32_16x16x32_bf16 v[148:151], v[136:139], v[72:75], 0
    v_mfma_f32_16x16x32_bf16 v[156:159], v[136:139], v[76:79], 0
    v_mfma_f32_16x16x32_bf16 v[152:155], v[136:139], v[208:211], 0
    v_mfma_f32_16x16x32_bf16 v[160:163], v[136:139], v[212:215], 0
    v_mfma_f32_16x16x32_bf16 v[148:151], v[144:147], v[76:79], v[148:151]
    v_mfma_f32_16x16x32_bf16 v[156:159], v[140:143], v[72:75], v[156:159]
    v_mfma_f32_16x16x32_bf16 v[152:155], v[144:147], v[212:215], v[152:155]
    v_mfma_f32_16x16x32_bf16 v[160:163], v[140:143], v[208:211], v[160:163]
    s_nop 5
    v_cvt_pk_bf16_f32 v164, v148, v156
    v_cvt_pk_bf16_f32 v165, v149, v157
    v_cvt_pk_bf16_f32 v166, v150, v158
    v_cvt_pk_bf16_f32 v167, v151, v159
    buffer_store_dwordx4 v[164:167], v10, s[28:31], s39 offen sc1
    v_cvt_pk_bf16_f32 v168, v152, v160
    v_cvt_pk_bf16_f32 v169, v153, v161
    v_cvt_pk_bf16_f32 v170, v154, v162
    v_cvt_pk_bf16_f32 v171, v155, v163
    buffer_store_dwordx4 v[168:171], v10, s[28:31], s43 offen sc1
    s_branch L_p1done
L_s1one:
    ds_read_b128 v[16:19], v7 offset:0
    ds_read_b128 v[20:23], v7 offset:10240
    ds_read_b128 v[24:27], v8 offset:0
    ds_read_b128 v[28:31], v8 offset:10240
    s_lshl_b32 s36, s41, 1
    s_add_u32 s36, s36, s37
    s_lshl_b32 s36, s36, 6
    s_add_u32 s36, s36, s40
    s_add_u32 s38, s36, 1310720
    s_lshl_b32 s39, s43, 1
    s_add_u32 s39, s39, s37
    s_lshl_b32 s39, s39, 6
    s_add_u32 s39, s39, s40
    s_add_u32 s43, s39, 1310720
    s_sub_u32 s46, 1, s37
    s_lshl_b32 s45, s3, 12
    s_add_u32 s45, s45, 126976
    v_cvt_f32_u32 v87, s46
    v_cvt_f32_u32 v88, s37
    v_mul_u32_u24 v10, 81920, v3
    v_lshl_add_u32 v10, v4, 4, v10
    v_mul_f32 v80, v87, v90
    v_mul_f32 v81, v88, v90
    v_mul_f32 v82, v87, v91
    v_mul_f32 v83, v88, v91
    v_lshlrev_b32 v216, 2, v4
    v_cvt_f32_u32 v217, v3
    ds_read_b128 v[32:35], v7 offset:128
    ds_read_b128 v[36:39], v7 offset:10368
    s_waitcnt lgkmcnt(4)
    v_mfma_f32_16x16x32_bf16 v[40:43], v[16:19], v[96:99], 0
    v_cvt_f32_u32 v216, v216
    v_mul_f32 v217, 0xbd000000, v217
    v_mfma_f32_16x16x32_bf16 v[44:47], v[20:23], v[96:99], 0
    v_and_b32 v230, 1, v3
    v_mul_f32 v218, v216, v217
    v_mfma_f32_16x16x32_bf16 v[48:51], v[16:19], v[116:119], 0
    v_mul_u32_u24 v230, 0x8000, v230
    v_add_f32 v219, v218, v217
    v_mfma_f32_16x16x32_bf16 v[52:55], v[20:23], v[116:119], 0
    ds_read_b128 v[16:19], v8 offset:128
    ds_read_b128 v[20:23], v8 offset:10368
    s_waitcnt lgkmcnt(4)
    v_mfma_f32_16x16x32_bf16 v[40:43], v[24:27], v[100:103], v[40:43]
    v_cos_f32 v222, v218
    v_add_f32 v220, v219, v217
    v_mfma_f32_16x16x32_bf16 v[44:47], v[28:31], v[100:103], v[44:47]
    v_sin_f32 v226, v218
    v_add_f32 v221, v220, v217
    v_mfma_f32_16x16x32_bf16 v[48:51], v[24:27], v[120:123], v[48:51]
    v_cos_f32 v223, v219
    v_lshl_or_b32 v230, v230, 16, v230
    v_mfma_f32_16x16x32_bf16 v[52:55], v[28:31], v[120:123], v[52:55]
    ds_read_b128 v[24:27], v7 offset:256
    ds_read_b128 v[28:31], v7 offset:10496
    s_waitcnt lgkmcnt(4)
    v_mfma_f32_16x16x32_bf16 v[40:43], v[32:35], v[104:107], v[40:43]
    v_sin_f32 v227, v219
    v_cos_f32 v224, v220
    v_mfma_f32_16x16x32_bf16 v[44:47], v[36:39], v[104:107], v[44:47]
    v_sin_f32 v228, v220
    v_cvt_pk_bf16_f32 v72, v222, v223
    v_mfma_f32_16x16x32_bf16 v[48:51], v[32:35], v[124:127], v[48:51]
    v_cos_f32 v225, v221
    v_cvt_pk_bf16_f32 v76, v226, v227
    v_mfma_f32_16x16x32_bf16 v[52:55], v[36:39], v[124:127], v[52:55]
    ds_read_b128 v[32:35], v8 offset:256
    ds_read_b128 v[36:39], v8 offset:10496
    s_waitcnt lgkmcnt(4)
    v_mfma_f32_16x16x32_bf16 v[40:43], v[16:19], v[108:111], v[40:43]
    v_sin_f32 v229, v221
    v_xor_b32 v74, v230, v72
    v_mfma_f32_16x16x32_bf16 v[44:47], v[20:23], v[108:111], v[44:47]
    v_cvt_pk_bf16_f32 v73, v224, v225
    v_cvt_pk_bf16_f32 v77, v228, v229
    v_mfma_f32_16x16x32_bf16 v[48:51], v[16:19], v[128:131], v[48:51]
    v_xor_b32 v78, v230, v76
    v_xor_b32 v75, v230, v73
    v_mfma_f32_16x16x32_bf16 v[52:55], v[20:23], v[128:131], v[52:55]
    ds_read_b128 v[16:19], v7 offset:384
    ds_read_b128 v[20:23], v7 offset:10624
    s_waitcnt lgkmcnt(4)
    v_mfma_f32_16x16x32_bf16 v[40:43], v[24:27], v[112:115], v[40:43]
    v_xor_b32 v79, v230, v77
    v_xor_b32 v208, s50, v72
    v_mfma_f32_16x16x32_bf16 v[44:47], v[28:31], v[112:115], v[44:47]
    v_xor_b32 v209, s50, v73
    v_xor_b32 v210, s50, v74
    v_mfma_f32_16x16x32_bf16 v[48:51], v[24:27], v[132:135], v[48:51]
    v_xor_b32 v211, s50, v75
    v_xor_b32 v212, s50, v76
    v_mfma_f32_16x16x32_bf16 v[52:55], v[28:31], v[132:135], v[52:55]
    ds_read_b128 v[24:27], v8 offset:384
    ds_read_b128 v[28:31], v8 offset:10624
    s_waitcnt lgkmcnt(4)
    v_mfma_f32_16x16x32_bf16 v[56:59], v[32:35], v[96:99], 0
    v_xor_b32 v213, s50, v77
    v_xor_b32 v214, s50, v78
    v_mfma_f32_16x16x32_bf16 v[60:63], v[36:39], v[96:99], 0
    v_xor_b32 v215, s50, v79
    v_mfma_f32_16x16x32_bf16 v[64:67], v[32:35], v[116:119], 0
    v_mfma_f32_16x16x32_bf16 v[68:71], v[36:39], v[116:119], 0
    ds_read_b128 v[32:35], v7 offset:512
    ds_read_b128 v[36:39], v7 offset:10752
    s_waitcnt lgkmcnt(4)
    v_mfma_f32_16x16x32_bf16 v[56:59], v[16:19], v[100:103], v[56:59]
    v_mfma_f32_16x16x32_bf16 v[60:63], v[20:23], v[100:103], v[60:63]
    v_mfma_f32_16x16x32_bf16 v[64:67], v[16:19], v[120:123], v[64:67]
    v_mfma_f32_16x16x32_bf16 v[68:71], v[20:23], v[120:123], v[68:71]
    ds_read_b128 v[16:19], v8 offset:512
    ds_read_b128 v[20:23], v8 offset:10752
    s_waitcnt lgkmcnt(4)
    v_mfma_f32_16x16x32_bf16 v[56:59], v[24:27], v[104:107], v[56:59]
    v_mfma_f32_16x16x32_bf16 v[60:63], v[28:31], v[104:107], v[60:63]
    v_mfma_f32_16x16x32_bf16 v[64:67], v[24:27], v[124:127], v[64:67]
    v_mfma_f32_16x16x32_bf16 v[68:71], v[28:31], v[124:127], v[68:71]
    s_waitcnt lgkmcnt(2)
    v_mfma_f32_16x16x32_bf16 v[56:59], v[32:35], v[108:111], v[56:59]
    v_mfma_f32_16x16x32_bf16 v[60:63], v[36:39], v[108:111], v[60:63]
    v_mfma_f32_16x16x32_bf16 v[64:67], v[32:35], v[128:131], v[64:67]
    v_mfma_f32_16x16x32_bf16 v[68:71], v[36:39], v[128:131], v[68:71]
    s_waitcnt lgkmcnt(0)
    v_mfma_f32_16x16x32_bf16 v[56:59], v[16:19], v[112:115], v[56:59]
    v_mfma_f32_16x16x32_bf16 v[60:63], v[20:23], v[112:115], v[60:63]
    v_mfma_f32_16x16x32_bf16 v[64:67], v[16:19], v[132:135], v[64:67]
    v_mfma_f32_16x16x32_bf16 v[68:71], v[20:23], v[132:135], v[68:71]
    s_nop 4
    v_pk_fma_f32 v[40:41], v[56:57], v[80:81], v[40:41] op_sel_hi:[1,0,1]
    s_nop 0
    v_pk_fma_f32 v[48:49], v[64:65], v[80:81], v[48:49] op_sel_hi:[1,0,1]
    v_pk_fma_f32 v[42:43], v[58:59], v[80:81], v[42:43] op_sel_hi:[1,0,1]
    v_pk_fma_f32 v[50:51], v[66:67], v[80:81], v[50:51] op_sel_hi:[1,0,1]
    v_pk_fma_f32 v[44:45], v[60:61], v[80:81], v[44:45] op_sel_hi:[1,0,1]
    v_pk_fma_f32 v[52:53], v[68:69], v[80:81], v[52:53] op_sel_hi:[1,0,1]
    v_pk_fma_f32 v[46:47], v[62:63], v[80:81], v[46:47] op_sel_hi:[1,0,1]
    v_pk_fma_f32 v[54:55], v[70:71], v[80:81], v[54:55] op_sel_hi:[1,0,1]
    v_pk_fma_f32 v[40:41], v[64:65], v[80:81], v[40:41] op_sel:[0,1,0] op_sel_hi:[1,1,1]
    v_pk_fma_f32 v[48:49], v[56:57], v[80:81], v[48:49] op_sel:[0,1,0] op_sel_hi:[1,1,1] neg_lo:[0,1,0] neg_hi:[0,1,0]
    v_pk_fma_f32 v[42:43], v[66:67], v[80:81], v[42:43] op_sel:[0,1,0] op_sel_hi:[1,1,1]
    v_pk_fma_f32 v[50:51], v[58:59], v[80:81], v[50:51] op_sel:[0,1,0] op_sel_hi:[1,1,1] neg_lo:[0,1,0] neg_hi:[0,1,0]
    v_pk_fma_f32 v[44:45], v[68:69], v[80:81], v[44:45] op_sel:[0,1,0] op_sel_hi:[1,1,1]
    v_pk_fma_f32 v[52:53], v[60:61], v[80:81], v[52:53] op_sel:[0,1,0] op_sel_hi:[1,1,1] neg_lo:[0,1,0] neg_hi:[0,1,0]
    v_pk_fma_f32 v[46:47], v[70:71], v[80:81], v[46:47] op_sel:[0,1,0] op_sel_hi:[1,1,1]
    v_pk_fma_f32 v[54:55], v[62:63], v[80:81], v[54:55] op_sel:[0,1,0] op_sel_hi:[1,1,1] neg_lo:[0,1,0] neg_hi:[0,1,0]
    v_cvt_pk_bf16_f32 v96, v40, v41
    v_cvt_pk_bf16_f32 v97, v42, v43
    v_cvt_pk_bf16_f32 v98, v44, v45
    v_cvt_pk_bf16_f32 v99, v46, v47
    v_cvt_pk_bf16_f32 v100, v48, v49
    v_cvt_pk_bf16_f32 v101, v50, v51
    v_cvt_pk_bf16_f32 v102, v52, v53
    v_cvt_pk_bf16_f32 v103, v54, v55
    v_xor_b32 v104, s51, v100
    v_xor_b32 v105, s51, v101
    v_xor_b32 v106, s51, v102
    v_xor_b32 v107, s51, v103
    v_mfma_f32_16x16x32_bf16 v[108:111], v[96:99], v[72:75], 0
    v_mfma_f32_16x16x32_bf16 v[116:119], v[96:99], v[76:79], 0
    v_mfma_f32_16x16x32_bf16 v[112:115], v[96:99], v[208:211], 0
    v_mfma_f32_16x16x32_bf16 v[120:123], v[96:99], v[212:215], 0
    v_mfma_f32_16x16x32_bf16 v[108:111], v[104:107], v[76:79], v[108:111]
    v_mfma_f32_16x16x32_bf16 v[116:119], v[100:103], v[72:75], v[116:119]
    v_mfma_f32_16x16x32_bf16 v[112:115], v[104:107], v[212:215], v[112:115]
    v_mfma_f32_16x16x32_bf16 v[120:123], v[100:103], v[208:211], v[120:123]
    s_nop 5
    v_cvt_pk_bf16_f32 v124, v108, v116
    v_cvt_pk_bf16_f32 v125, v109, v117
    v_cvt_pk_bf16_f32 v126, v110, v118
    v_cvt_pk_bf16_f32 v127, v111, v119
    buffer_store_dwordx4 v[124:127], v10, s[28:31], s36 offen sc1
    v_cvt_pk_bf16_f32 v128, v112, v120
    v_cvt_pk_bf16_f32 v129, v113, v121
    v_cvt_pk_bf16_f32 v130, v114, v122
    v_cvt_pk_bf16_f32 v131, v115, v123
    buffer_store_dwordx4 v[128:131], v10, s[28:31], s38 offen sc1
L_p1done:
    s_lshr_b32 s47, s2, 6
    s_bfe_u32 s48, s2, 0x30003
    s_bfe_u32 s16, s2, 0x20001
    s_lshl_b32 s16, s16, 2
    s_add_u32 s16, s16, s47
    s_and_b32 s18, s2, 1
    s_lshl_b32 s18, s18, 3
    s_add_u32 s18, s18, s48
    s_lshr_b32 s42, s18, 2
    s_mul_i32 s17, s42, 27
    s_and_b32 s42, s18, 3
    s_mul_i32 s49, s42, 7
    s_add_u32 s17, s17, s49
    s_lshl_b32 s23, s16, 3
    s_lshl_b32 s49, s3, 1
    s_add_u32 s23, s23, s49
    s_mul_i32 s64, s23, 55296
    s_lshl_b32 s49, s17, 9
    s_add_u32 s64, s64, s49
    s_add_u32 s64, s64, 12582912
    s_cmp_eq_u32 s42, 3
    s_cselect_b32 s65, 1073741824, s64
    s_lshl_b32 s66, s16, 4
    s_add_u32 s66, s66, s18
    s_lshl_b32 s66, s66, 2
    s_add_u32 s66, s66, s3
    s_lshl_b32 s66, s66, 7
    s_add_u32 s66, s66, 26345472
    s_and_b32 s26, s2, 7
    s_lshl_b32 s26, s26, 1
    s_lshr_b32 s42, s47, 1
    s_add_u32 s26, s26, s42
    s_sub_u32 s42, 32, s26
    s_cmp_eq_u32 s26, 0
    s_cselect_b32 s42, 16, s42
    s_bitcmp1_b32 s47, 0
    s_cselect_b32 s26, s42, s26
    s_mul_i32 s27, s48, 5
    s_add_u32 s27, s27, 1
    s_lshr_b32 s27, s27, 1
    s_add_u32 s27, s27, s3
    s_mul_i32 s60, s26, 81920
    s_lshl_b32 s49, s27, 10
    s_add_u32 s60, s60, s49
    s_add_u32 s60, s60, 4194304
    s_mul_i32 s62, s26, 10240
    s_lshl_b32 s49, s27, 7
    s_add_u32 s62, s62, s49
    s_add_u32 s62, s62, 8388608
    s_mul_i32 s63, s26, 2560
    s_add_u32 s63, s63, s49
    s_add_u32 s63, s63, 26247168
    s_and_b32 s42, s48, 1
    s_sub_u32 s42, 3, s42
    s_cmp_lt_u32 s3, s42
    s_cselect_b32 s67, 1, 0
    s_cselect_b32 s60, s60, 1073741824
    s_cselect_b32 s62, s62, 1073741824
    s_add_u32 s61, s60, 40960
    s_bfe_u32 s19, s2, 0x20001
    s_lshl_b32 s19, s19, 3
    s_lshr_b32 s49, s2, 5
    s_add_u32 s19, s19, s49
    s_and_b32 s20, s2, 1
    s_lshl_b32 s20, s20, 2
    s_bfe_u32 s49, s2, 0x20003
    s_add_u32 s20, s20, s49
    s_mul_i32 s21, s20, 54
    s_mul_i32 s22, s3, 14
    s_add_u32 s21, s21, s22
    s_mul_i32 s21, s21, 5120
    s_add_u32 s21, s21, 20971520
    s_lshl_b32 s22, s22, 10
    s_add_u32 s22, s22, 12582912
    s_cmp_eq_u32 s3, 3
    s_cselect_b32 s49, 1073741824, 0
    v_lshlrev_b32 v12, 4, v1
    v_or_b32 v13, s49, v12
    s_lshr_b32 s58, s2, 3
    s_lshl_b32 s58, s58, 7
    s_and_b32 s55, s2, 7
    s_lshl_b32 s55, s55, 2
    s_add_u32 s58, s58, s55
    s_add_u32 s58, s58, 26542080
    s_cmp_eq_u32 s67, 0
    s_cbranch_scc1 L_idle
    v_and_b32 v3, 31, v1
    v_lshrrev_b32 v4, 5, v1
    v_lshrrev_b32 v7, 2, v1
    v_mul_u32_u24 v10, 40960, v7
    v_and_b32 v7, 3, v1
    v_lshl_add_u32 v10, v7, 4, v10
    s_mul_i32 s49, s26, 1280
    s_lshl_b32 s50, s27, 6
    s_add_u32 s49, s49, s50
    s_lshl_b32 s51, s3, 12
    s_add_u32 s51, s51, 143360
    s_sub_u32 s39, 32, s26
    s_and_b32 s39, s39, 31
    s_sub_u32 s41, 19, s27
    s_cmp_ge_u32 s27, 10
    s_cselect_b32 s39, s39, s26
    s_cselect_b32 s40, s41, s27
    s_mul_i32 s39, s39, 81920
    s_lshl_b32 s40, s40, 7
    v_lshlrev_b32 v5, 2, v3
    s_cmp_ge_u32 s27, 10
    s_cbranch_scc0 L_p2_direct
    v_lshrrev_b32 v6, 4, v3
    v_mul_u32_u24 v6, 124, v6
    v_sub_u32 v5, v6, v5
    v_add_u32 v5, 64, v5
    s_movk_i32 s41, 128
    s_cmp_eq_u32 s27, 10
    s_cselect_b32 s41, -1152, s41
    v_mov_b32 v6, s41
    s_branch L_p2_fix
L_p2_direct:
    s_cmp_eq_u32 s27, 0
    s_cselect_b32 s41, 1073741824, 0
    v_mov_b32 v6, s41
L_p2_fix:
    v_cmp_eq_u32 vcc, 0, v3
    s_nop 1
    v_cndmask_b32 v5, v5, v6, vcc
    v_add_u32 v5, s40, v5
    v_mul_u32_u24 v6, 40960, v4
    v_add_u32 v5, v5, v6
    s_add_u32 s39, s39, 0
    s_mov_b32 s50, 0x80008000
    s_cmp_ge_u32 s27, 10
    s_cselect_b32 s46, 0x80000000, 0
    s_or_b32 s46, s46, 0x3a000000
    v_lshl_add_u32 v8, v3, 5, s26
    v_cvt_f32_u32 v8, v8
    v_lshlrev_b32 v9, 5, v4
    v_cvt_f32_u32 v9, v9
    v_mul_f32 v8, s46, v8
    v_mul_f32 v9, v9, v8
    v_mov_b32 v16, v9
    v_fmamk_f32 v17, v8, 0x3f800000, v9
    v_fmamk_f32 v18, v8, 0x40000000, v9
    v_fmamk_f32 v19, v8, 0x40400000, v9
    v_cos_f32 v20, v16
    v_sin_f32 v24, v16
    v_cos_f32 v21, v17
    v_sin_f32 v25, v17
    v_cos_f32 v22, v18
    v_sin_f32 v26, v18
    v_cos_f32 v23, v19
    v_sin_f32 v27, v19
    v_cvt_pk_bf16_f32 v96, v20, v24
    v_cvt_pk_bf16_f32 v97, v21, v25
    v_cvt_pk_bf16_f32 v98, v22, v26
    v_cvt_pk_bf16_f32 v99, v23, v27
    v_mov_b32 v128, v96
    v_xor_b32 v129, s50, v97
    v_mov_b32 v130, v98
    v_xor_b32 v131, s50, v99
    v_fmamk_f32 v16, v8, 0x40800000, v9
    v_fmamk_f32 v17, v8, 0x40a00000, v9
    v_fmamk_f32 v18, v8, 0x40c00000, v9
    v_fmamk_f32 v19, v8, 0x40e00000, v9
    v_cos_f32 v20, v16
    v_sin_f32 v24, v16
    v_cos_f32 v21, v17
    v_sin_f32 v25, v17
    v_cos_f32 v22, v18
    v_sin_f32 v26, v18
    v_cos_f32 v23, v19
    v_sin_f32 v27, v19
    v_cvt_pk_bf16_f32 v100, v20, v24
    v_cvt_pk_bf16_f32 v101, v21, v25
    v_cvt_pk_bf16_f32 v102, v22, v26
    v_cvt_pk_bf16_f32 v103, v23, v27
    v_mov_b32 v132, v100
    v_xor_b32 v133, s50, v101
    v_mov_b32 v134, v102
    v_xor_b32 v135, s50, v103
    v_fmamk_f32 v16, v8, 0x41000000, v9
    v_fmamk_f32 v17, v8, 0x41100000, v9
    v_fmamk_f32 v18, v8, 0x41200000, v9
    v_fmamk_f32 v19, v8, 0x41300000, v9
    v_cos_f32 v20, v16
    v_sin_f32 v24, v16
    v_cos_f32 v21, v17
    v_sin_f32 v25, v17
    v_cos_f32 v22, v18
    v_sin_f32 v26, v18
    v_cos_f32 v23, v19
    v_sin_f32 v27, v19
    v_cvt_pk_bf16_f32 v104, v20, v24
    v_cvt_pk_bf16_f32 v105, v21, v25
    v_cvt_pk_bf16_f32 v106, v22, v26
    v_cvt_pk_bf16_f32 v107, v23, v27
    v_mov_b32 v136, v104
    v_xor_b32 v137, s50, v105
    v_mov_b32 v138, v106
    v_xor_b32 v139, s50, v107
    v_fmamk_f32 v16, v8, 0x41400000, v9
    v_fmamk_f32 v17, v8, 0x41500000, v9
    v_fmamk_f32 v18, v8, 0x41600000, v9
    v_fmamk_f32 v19, v8, 0x41700000, v9
    v_cos_f32 v20, v16
    v_sin_f32 v24, v16
    v_cos_f32 v21, v17
    v_sin_f32 v25, v17
    v_cos_f32 v22, v18
    v_sin_f32 v26, v18
    v_cos_f32 v23, v19
    v_sin_f32 v27, v19
    v_cvt_pk_bf16_f32 v108, v20, v24
    v_cvt_pk_bf16_f32 v109, v21, v25
    v_cvt_pk_bf16_f32 v110, v22, v26
    v_cvt_pk_bf16_f32 v111, v23, v27
    v_mov_b32 v140, v108
    v_xor_b32 v141, s50, v109
    v_mov_b32 v142, v110
    v_xor_b32 v143, s50, v111
    v_fmamk_f32 v16, v8, 0x41800000, v9
    v_fmamk_f32 v17, v8, 0x41880000, v9
    v_fmamk_f32 v18, v8, 0x41900000, v9
    v_fmamk_f32 v19, v8, 0x41980000, v9
    v_cos_f32 v20, v16
    v_sin_f32 v24, v16
    v_cos_f32 v21, v17
    v_sin_f32 v25, v17
    v_cos_f32 v22, v18
    v_sin_f32 v26, v18
    v_cos_f32 v23, v19
    v_sin_f32 v27, v19
    v_cvt_pk_bf16_f32 v112, v20, v24
    v_cvt_pk_bf16_f32 v113, v21, v25
    v_cvt_pk_bf16_f32 v114, v22, v26
    v_cvt_pk_bf16_f32 v115, v23, v27
    v_mov_b32 v144, v112
    v_xor_b32 v145, s50, v113
    v_mov_b32 v146, v114
    v_xor_b32 v147, s50, v115
    v_fmamk_f32 v16, v8, 0x41a00000, v9
    v_fmamk_f32 v17, v8, 0x41a80000, v9
    v_fmamk_f32 v18, v8, 0x41b00000, v9
    v_fmamk_f32 v19, v8, 0x41b80000, v9
    v_cos_f32 v20, v16
    v_sin_f32 v24, v16
    v_cos_f32 v21, v17
    v_sin_f32 v25, v17
    v_cos_f32 v22, v18
    v_sin_f32 v26, v18
    v_cos_f32 v23, v19
    v_sin_f32 v27, v19
    v_cvt_pk_bf16_f32 v116, v20, v24
    v_cvt_pk_bf16_f32 v117, v21, v25
    v_cvt_pk_bf16_f32 v118, v22, v26
    v_cvt_pk_bf16_f32 v119, v23, v27
    v_mov_b32 v148, v116
    v_xor_b32 v149, s50, v117
    v_mov_b32 v150, v118
    v_xor_b32 v151, s50, v119
    v_fmamk_f32 v16, v8, 0x41c00000, v9
    v_fmamk_f32 v17, v8, 0x41c80000, v9
    v_fmamk_f32 v18, v8, 0x41d00000, v9
    v_fmamk_f32 v19, v8, 0x41d80000, v9
    v_cos_f32 v20, v16
    v_sin_f32 v24, v16
    v_cos_f32 v21, v17
    v_sin_f32 v25, v17
    v_cos_f32 v22, v18
    v_sin_f32 v26, v18
    v_cos_f32 v23, v19
    v_sin_f32 v27, v19
    v_cvt_pk_bf16_f32 v120, v20, v24
    v_cvt_pk_bf16_f32 v121, v21, v25
    v_cvt_pk_bf16_f32 v122, v22, v26
    v_cvt_pk_bf16_f32 v123, v23, v27
    v_mov_b32 v152, v120
    v_xor_b32 v153, s50, v121
    v_mov_b32 v154, v122
    v_xor_b32 v155, s50, v123
    v_fmamk_f32 v16, v8, 0x41e00000, v9
    v_fmamk_f32 v17, v8, 0x41e80000, v9
    v_fmamk_f32 v18, v8, 0x41f00000, v9
    v_fmamk_f32 v19, v8, 0x41f80000, v9
    v_cos_f32 v20, v16
    v_sin_f32 v24, v16
    v_cos_f32 v21, v17
    v_sin_f32 v25, v17
    v_cos_f32 v22, v18
    v_sin_f32 v26, v18
    v_cos_f32 v23, v19
    v_sin_f32 v27, v19
    v_cvt_pk_bf16_f32 v124, v20, v24
    v_cvt_pk_bf16_f32 v125, v21, v25
    v_cvt_pk_bf16_f32 v126, v22, v26
    v_cvt_pk_bf16_f32 v127, v23, v27
    v_mov_b32 v156, v124
    v_xor_b32 v157, s50, v125
    v_mov_b32 v158, v126
    v_xor_b32 v159, s50, v127
    s_waitcnt vmcnt(0)
    v_mov_b32 v76, 139264
    v_mov_b32 v77, 1
    s_mov_b64 exec, 1
    ds_add_rtn_u32 v78, v76, v77
    s_mov_b64 exec, -1
    s_waitcnt lgkmcnt(0)
    v_readfirstlane_b32 s47, v78
    s_nop 1
    s_cmp_lg_u32 s47, 2
    s_cbranch_scc1 L_notlast_p
    v_mov_b32 v76, s24
    v_mov_b32 v77, s25
    v_mov_b32 v78, 0
    s_mov_b64 exec, 1
    buffer_store_dword v76, v78, s[28:31], s58 offen sc1
    s_mov_b64 exec, -1
L_notlast_p:
    v_mov_b32 v76, 139264
L_cw_p:
    ds_read_b32 v77, v76
    s_waitcnt lgkmcnt(0)
    v_cmp_gt_u32 vcc, 3, v77
    s_cbranch_vccnz L_cw_p
    s_add_u32 m0, s51, 0
    s_nop 0
    buffer_load_dwordx4 v10, s[4:7], s49 offen lds
    s_add_u32 s49, s49, 655360
    s_add_u32 m0, s51, 1024
    s_nop 0
    buffer_load_dwordx4 v10, s[4:7], s49 offen lds
    s_add_u32 s49, s49, 655360
    s_add_u32 m0, s51, 2048
    s_nop 0
    buffer_load_dwordx4 v10, s[4:7], s49 offen lds
    s_add_u32 s49, s49, 655360
    s_add_u32 m0, s51, 3072
    s_nop 0
    buffer_load_dwordx4 v10, s[4:7], s49 offen lds
    v_lshlrev_b32 v7, 6, v3
    v_lshl_add_u32 v7, v4, 4, v7
    v_add_u32 v7, s51, v7
    s_mov_b32 s48, 0xffff0000
    s_waitcnt vmcnt(0)
    ds_read_b128 v[60:63], v7 offset:0
    ds_read_b128 v[64:67], v7 offset:32
    ds_read_b128 v[68:71], v7 offset:2048
    ds_read_b128 v[72:75], v7 offset:2080
    s_waitcnt lgkmcnt(3)
    v_lshlrev_b32 v160, 16, v60
    v_and_b32 v168, s48, v60
    v_lshlrev_b32 v161, 16, v61
    v_and_b32 v169, s48, v61
    v_lshlrev_b32 v162, 16, v62
    v_and_b32 v170, s48, v62
    v_lshlrev_b32 v163, 16, v63
    v_and_b32 v171, s48, v63
    s_waitcnt lgkmcnt(2)
    v_lshlrev_b32 v164, 16, v64
    v_and_b32 v172, s48, v64
    v_lshlrev_b32 v165, 16, v65
    v_and_b32 v173, s48, v65
    v_lshlrev_b32 v166, 16, v66
    v_and_b32 v174, s48, v66
    v_lshlrev_b32 v167, 16, v67
    v_and_b32 v175, s48, v67
    s_waitcnt lgkmcnt(1)
    v_lshlrev_b32 v176, 16, v68
    v_and_b32 v184, s48, v68
    v_lshlrev_b32 v177, 16, v69
    v_and_b32 v185, s48, v69
    v_lshlrev_b32 v178, 16, v70
    v_and_b32 v186, s48, v70
    v_lshlrev_b32 v179, 16, v71
    v_and_b32 v187, s48, v71
    s_waitcnt lgkmcnt(0)
    v_lshlrev_b32 v180, 16, v72
    v_and_b32 v188, s48, v72
    v_lshlrev_b32 v181, 16, v73
    v_and_b32 v189, s48, v73
    v_lshlrev_b32 v182, 16, v74
    v_and_b32 v190, s48, v74
    v_lshlrev_b32 v183, 16, v75
    v_and_b32 v191, s48, v75
    v_bfe_u32 v10, v1, 4, 1
    v_mul_u32_u24 v10, 20480, v10
    v_lshrrev_b32 v6, 5, v1
    v_lshl_add_u32 v10, v6, 8, v10
    v_and_b32 v6, 15, v1
    v_lshl_add_u32 v10, v6, 4, v10
    v_lshrrev_b32 v7, 4, v1
    v_mul_u32_u24 v7, 2560, v7
    v_and_b32 v6, 15, v1
    v_lshl_add_u32 v7, v6, 3, v7
    s_barrier
    s_barrier
    buffer_load_dword v28, v5, s[28:31], s39 offen offset:0 sc1
    buffer_load_dword v29, v5, s[28:31], s39 offen offset:1280 sc1
    buffer_load_dword v30, v5, s[28:31], s39 offen offset:2560 sc1
    buffer_load_dword v31, v5, s[28:31], s39 offen offset:3840 sc1
    s_add_u32 s39, s39, 5120
    buffer_load_dword v32, v5, s[28:31], s39 offen offset:0 sc1
    buffer_load_dword v33, v5, s[28:31], s39 offen offset:1280 sc1
    buffer_load_dword v34, v5, s[28:31], s39 offen offset:2560 sc1
    buffer_load_dword v35, v5, s[28:31], s39 offen offset:3840 sc1
    s_add_u32 s39, s39, 5120
    buffer_load_dword v36, v5, s[28:31], s39 offen offset:0 sc1
    buffer_load_dword v37, v5, s[28:31], s39 offen offset:1280 sc1
    buffer_load_dword v38, v5, s[28:31], s39 offen offset:2560 sc1
    buffer_load_dword v39, v5, s[28:31], s39 offen offset:3840 sc1
    s_add_u32 s39, s39, 5120
    buffer_load_dword v40, v5, s[28:31], s39 offen offset:0 sc1
    buffer_load_dword v41, v5, s[28:31], s39 offen offset:1280 sc1
    buffer_load_dword v42, v5, s[28:31], s39 offen offset:2560 sc1
    buffer_load_dword v43, v5, s[28:31], s39 offen offset:3840 sc1
    s_add_u32 s39, s39, 5120
    buffer_load_dword v44, v5, s[28:31], s39 offen offset:0 sc1
    buffer_load_dword v45, v5, s[28:31], s39 offen offset:1280 sc1
    buffer_load_dword v46, v5, s[28:31], s39 offen offset:2560 sc1
    buffer_load_dword v47, v5, s[28:31], s39 offen offset:3840 sc1
    s_add_u32 s39, s39, 5120
    buffer_load_dword v48, v5, s[28:31], s39 offen offset:0 sc1
    buffer_load_dword v49, v5, s[28:31], s39 offen offset:1280 sc1
    buffer_load_dword v50, v5, s[28:31], s39 offen offset:2560 sc1
    buffer_load_dword v51, v5, s[28:31], s39 offen offset:3840 sc1
    s_add_u32 s39, s39, 5120
    buffer_load_dword v52, v5, s[28:31], s39 offen offset:0 sc1
    buffer_load_dword v53, v5, s[28:31], s39 offen offset:1280 sc1
    buffer_load_dword v54, v5, s[28:31], s39 offen offset:2560 sc1
    buffer_load_dword v55, v5, s[28:31], s39 offen offset:3840 sc1
    s_add_u32 s39, s39, 5120
    buffer_load_dword v56, v5, s[28:31], s39 offen offset:0 sc1
    buffer_load_dword v57, v5, s[28:31], s39 offen offset:1280 sc1
    buffer_load_dword v58, v5, s[28:31], s39 offen offset:2560 sc1
    buffer_load_dword v59, v5, s[28:31], s39 offen offset:3840 sc1
    s_waitcnt vmcnt(28)
    v_mfma_f32_32x32x16_bf16 v[160:175], v[28:31], v[96:99], v[160:175]
    v_mfma_f32_32x32x16_bf16 v[176:191], v[28:31], v[128:131], v[176:191]
    s_waitcnt vmcnt(24)
    v_mfma_f32_32x32x16_bf16 v[160:175], v[32:35], v[100:103], v[160:175]
    v_mfma_f32_32x32x16_bf16 v[176:191], v[32:35], v[132:135], v[176:191]
    s_waitcnt vmcnt(20)
    v_mfma_f32_32x32x16_bf16 v[160:175], v[36:39], v[104:107], v[160:175]
    v_mfma_f32_32x32x16_bf16 v[176:191], v[36:39], v[136:139], v[176:191]
    s_waitcnt vmcnt(16)
    v_mfma_f32_32x32x16_bf16 v[160:175], v[40:43], v[108:111], v[160:175]
    v_mfma_f32_32x32x16_bf16 v[176:191], v[40:43], v[140:143], v[176:191]
    s_waitcnt vmcnt(12)
    v_mfma_f32_32x32x16_bf16 v[160:175], v[44:47], v[112:115], v[160:175]
    v_mfma_f32_32x32x16_bf16 v[176:191], v[44:47], v[144:147], v[176:191]
    s_waitcnt vmcnt(8)
    v_mfma_f32_32x32x16_bf16 v[160:175], v[48:51], v[116:119], v[160:175]
    v_mfma_f32_32x32x16_bf16 v[176:191], v[48:51], v[148:151], v[176:191]
    s_waitcnt vmcnt(4)
    v_mfma_f32_32x32x16_bf16 v[160:175], v[52:55], v[120:123], v[160:175]
    v_mfma_f32_32x32x16_bf16 v[176:191], v[52:55], v[152:155], v[176:191]
    s_waitcnt vmcnt(0)
    v_mfma_f32_32x32x16_bf16 v[160:175], v[56:59], v[124:127], v[160:175]
    v_mfma_f32_32x32x16_bf16 v[176:191], v[56:59], v[156:159], v[176:191]
    s_nop 10
    v_cvt_pk_bf16_f32 v28, v160, v168
    v_cvt_pk_bf16_f32 v29, v161, v169
    v_cvt_pk_bf16_f32 v30, v162, v170
    v_cvt_pk_bf16_f32 v31, v163, v171
    buffer_store_dwordx4 v[28:31], v10, s[28:31], s60 offen offset:0 sc1
    v_cvt_pk_bf16_f32 v32, v164, v172
    v_cvt_pk_bf16_f32 v33, v165, v173
    v_cvt_pk_bf16_f32 v34, v166, v174
    v_cvt_pk_bf16_f32 v35, v167, v175
    buffer_store_dwordx4 v[32:35], v10, s[28:31], s60 offen offset:512 sc1
    v_cvt_pk_bf16_f32 v36, v176, v184
    v_cvt_pk_bf16_f32 v37, v177, v185
    v_cvt_pk_bf16_f32 v38, v178, v186
    v_cvt_pk_bf16_f32 v39, v179, v187
    buffer_store_dwordx4 v[36:39], v10, s[28:31], s61 offen offset:0 sc1
    v_cvt_pk_bf16_f32 v40, v180, v188
    v_cvt_pk_bf16_f32 v41, v181, v189
    v_cvt_pk_bf16_f32 v42, v182, v190
    v_cvt_pk_bf16_f32 v43, v183, v191
    buffer_store_dwordx4 v[40:43], v10, s[28:31], s61 offen offset:512 sc1
    v_pk_add_f32 v[20:21], v[160:161], v[162:163]
    v_pk_mul_f32 v[22:23], v[160:161], v[160:161]
    v_pk_add_f32 v[24:25], v[164:165], v[166:167]
    v_pk_mul_f32 v[26:27], v[162:163], v[162:163]
    v_pk_add_f32 v[20:21], v[20:21], v[168:169]
    v_pk_add_f32 v[24:25], v[24:25], v[170:171]
    v_pk_add_f32 v[20:21], v[20:21], v[172:173]
    v_pk_add_f32 v[24:25], v[24:25], v[174:175]
    v_pk_fma_f32 v[22:23], v[164:165], v[164:165], v[22:23]
    v_pk_fma_f32 v[26:27], v[166:167], v[166:167], v[26:27]
    v_pk_fma_f32 v[22:23], v[168:169], v[168:169], v[22:23]
    v_pk_fma_f32 v[26:27], v[170:171], v[170:171], v[26:27]
    v_pk_fma_f32 v[22:23], v[172:173], v[172:173], v[22:23]
    v_pk_fma_f32 v[26:27], v[174:175], v[174:175], v[26:27]
    v_pk_add_f32 v[20:21], v[20:21], v[24:25]
    v_pk_add_f32 v[22:23], v[22:23], v[26:27]
    v_add_f32 v16, v20, v21
    v_add_f32 v17, v22, v23
    v_pk_add_f32 v[20:21], v[176:177], v[178:179]
    v_pk_mul_f32 v[22:23], v[176:177], v[176:177]
    v_pk_add_f32 v[24:25], v[180:181], v[182:183]
    v_pk_mul_f32 v[26:27], v[178:179], v[178:179]
    v_pk_add_f32 v[20:21], v[20:21], v[184:185]
    v_pk_add_f32 v[24:25], v[24:25], v[186:187]
    v_pk_add_f32 v[20:21], v[20:21], v[188:189]
    v_pk_add_f32 v[24:25], v[24:25], v[190:191]
    v_pk_fma_f32 v[22:23], v[180:181], v[180:181], v[22:23]
    v_pk_fma_f32 v[26:27], v[182:183], v[182:183], v[26:27]
    v_pk_fma_f32 v[22:23], v[184:185], v[184:185], v[22:23]
    v_pk_fma_f32 v[26:27], v[186:187], v[186:187], v[26:27]
    v_pk_fma_f32 v[22:23], v[188:189], v[188:189], v[22:23]
    v_pk_fma_f32 v[26:27], v[190:191], v[190:191], v[26:27]
    v_pk_add_f32 v[20:21], v[20:21], v[24:25]
    v_pk_add_f32 v[22:23], v[22:23], v[26:27]
    v_add_f32 v18, v20, v21
    v_add_f32 v19, v22, v23
    s_nop 0
    v_permlane32_swap_b32 v16, v18
    v_permlane32_swap_b32 v17, v19
    v_pk_add_f32 v[16:17], v[16:17], v[18:19]
    buffer_store_dwordx2 v[16:17], v7, s[28:31], s62 offen sc1
    s_waitcnt vmcnt(0)
    v_mov_b32 v8, s24
    v_mov_b32 v9, s25
    v_mov_b32 v10, 0
    s_mov_b64 exec, 1
    buffer_store_dwordx2 v[8:9], v10, s[28:31], s63 offen sc1
    s_mov_b64 exec, -1
    s_branch L_join
L_idle:
    s_waitcnt vmcnt(0)
    v_mov_b32 v16, 139264
    v_mov_b32 v17, 1
    s_mov_b64 exec, 1
    ds_add_rtn_u32 v18, v16, v17
    s_mov_b64 exec, -1
    s_waitcnt lgkmcnt(0)
    v_readfirstlane_b32 s47, v18
    s_nop 1
    s_cmp_lg_u32 s47, 2
    s_cbranch_scc1 L_notlast_i
    v_mov_b32 v16, s24
    v_mov_b32 v17, s25
    v_mov_b32 v18, 0
    s_mov_b64 exec, 1
    buffer_store_dword v16, v18, s[28:31], s58 offen sc1
    s_mov_b64 exec, -1
L_notlast_i:
    s_barrier
    s_barrier
    s_branch L_join
L_loader1:
    s_lshr_b32 s47, s2, 6
    s_bfe_u32 s48, s2, 0x30003
    s_bfe_u32 s16, s2, 0x20001
    s_lshl_b32 s16, s16, 2
    s_add_u32 s16, s16, s47
    s_and_b32 s18, s2, 1
    s_lshl_b32 s18, s18, 3
    s_add_u32 s18, s18, s48
    s_lshr_b32 s42, s18, 2
    s_mul_i32 s17, s42, 27
    s_and_b32 s42, s18, 3
    s_mul_i32 s49, s42, 7
    s_add_u32 s17, s17, s49
    s_lshl_b32 s23, s16, 3
    s_lshl_b32 s49, s3, 1
    s_add_u32 s23, s23, s49
    s_mul_i32 s64, s23, 55296
    s_lshl_b32 s49, s17, 9
    s_add_u32 s64, s64, s49
    s_add_u32 s64, s64, 12582912
    s_cmp_eq_u32 s42, 3
    s_cselect_b32 s65, 1073741824, s64
    s_lshl_b32 s66, s16, 4
    s_add_u32 s66, s66, s18
    s_lshl_b32 s66, s66, 2
    s_add_u32 s66, s66, s3
    s_lshl_b32 s66, s66, 7
    s_add_u32 s66, s66, 26345472
    s_and_b32 s26, s2, 7
    s_lshl_b32 s26, s26, 1
    s_lshr_b32 s42, s47, 1
    s_add_u32 s26, s26, s42
    s_sub_u32 s42, 32, s26
    s_cmp_eq_u32 s26, 0
    s_cselect_b32 s42, 16, s42
    s_bitcmp1_b32 s47, 0
    s_cselect_b32 s26, s42, s26
    s_mul_i32 s27, s48, 5
    s_add_u32 s27, s27, 1
    s_lshr_b32 s27, s27, 1
    s_add_u32 s27, s27, s3
    s_mul_i32 s60, s26, 81920
    s_lshl_b32 s49, s27, 10
    s_add_u32 s60, s60, s49
    s_add_u32 s60, s60, 4194304
    s_mul_i32 s62, s26, 10240
    s_lshl_b32 s49, s27, 7
    s_add_u32 s62, s62, s49
    s_add_u32 s62, s62, 8388608
    s_mul_i32 s63, s26, 2560
    s_add_u32 s63, s63, s49
    s_add_u32 s63, s63, 26247168
    s_and_b32 s42, s48, 1
    s_sub_u32 s42, 3, s42
    s_cmp_lt_u32 s3, s42
    s_cselect_b32 s67, 1, 0
    s_cselect_b32 s60, s60, 1073741824
    s_cselect_b32 s62, s62, 1073741824
    s_add_u32 s61, s60, 40960
    s_bfe_u32 s19, s2, 0x20001
    s_lshl_b32 s19, s19, 3
    s_lshr_b32 s49, s2, 5
    s_add_u32 s19, s19, s49
    s_and_b32 s20, s2, 1
    s_lshl_b32 s20, s20, 2
    s_bfe_u32 s49, s2, 0x20003
    s_add_u32 s20, s20, s49
    s_mul_i32 s21, s20, 54
    s_mul_i32 s22, s3, 14
    s_add_u32 s21, s21, s22
    s_mul_i32 s21, s21, 5120
    s_add_u32 s21, s21, 20971520
    s_lshl_b32 s22, s22, 10
    s_add_u32 s22, s22, 12582912
    s_cmp_eq_u32 s3, 3
    s_cselect_b32 s49, 1073741824, 0
    v_lshlrev_b32 v12, 4, v1
    v_or_b32 v13, s49, v12
    v_add_u32 v56, 0, v1
    v_mul_u32_u24 v57, 4682, v56
    v_lshrrev_b32 v57, 16, v57
    v_mul_u32_u24 v58, 14, v57
    v_sub_u32 v56, v56, v58
    v_bfe_u32 v58, v57, 2, 2
    v_lshlrev_b32 v58, 3, v58
    v_and_or_b32 v58, v57, 3, v58
    v_lshrrev_b32 v57, 4, v57
    v_lshl_add_u32 v58, v57, 2, v58
    v_mul_u32_u24 v58, 3456, v58
    v_lshl_add_u32 v80, v56, 4, v58
    v_add_u32 v56, 64, v1
    v_mul_u32_u24 v57, 4682, v56
    v_lshrrev_b32 v57, 16, v57
    v_mul_u32_u24 v58, 14, v57
    v_sub_u32 v56, v56, v58
    v_bfe_u32 v58, v57, 2, 2
    v_lshlrev_b32 v58, 3, v58
    v_and_or_b32 v58, v57, 3, v58
    v_lshrrev_b32 v57, 4, v57
    v_lshl_add_u32 v58, v57, 2, v58
    v_mul_u32_u24 v58, 3456, v58
    v_lshl_add_u32 v81, v56, 4, v58
    v_add_u32 v56, 128, v1
    v_mul_u32_u24 v57, 4682, v56
    v_lshrrev_b32 v57, 16, v57
    v_mul_u32_u24 v58, 14, v57
    v_sub_u32 v56, v56, v58
    v_bfe_u32 v58, v57, 2, 2
    v_lshlrev_b32 v58, 3, v58
    v_and_or_b32 v58, v57, 3, v58
    v_lshrrev_b32 v57, 4, v57
    v_lshl_add_u32 v58, v57, 2, v58
    v_mul_u32_u24 v58, 3456, v58
    v_lshl_add_u32 v82, v56, 4, v58
    v_add_u32 v56, 192, v1
    v_mul_u32_u24 v57, 4682, v56
    v_lshrrev_b32 v57, 16, v57
    v_mul_u32_u24 v58, 14, v57
    v_sub_u32 v56, v56, v58
    v_bfe_u32 v58, v57, 2, 2
    v_lshlrev_b32 v58, 3, v58
    v_and_or_b32 v58, v57, 3, v58
    v_lshrrev_b32 v57, 4, v57
    v_lshl_add_u32 v58, v57, 2, v58
    v_mul_u32_u24 v58, 3456, v58
    v_lshl_add_u32 v83, v56, 4, v58
    v_add_u32 v56, 256, v1
    v_mul_u32_u24 v57, 4682, v56
    v_lshrrev_b32 v57, 16, v57
    v_mul_u32_u24 v58, 14, v57
    v_sub_u32 v56, v56, v58
    v_bfe_u32 v58, v57, 2, 2
    v_lshlrev_b32 v58, 3, v58
    v_and_or_b32 v58, v57, 3, v58
    v_lshrrev_b32 v57, 4, v57
    v_lshl_add_u32 v58, v57, 2, v58
    v_mul_u32_u24 v58, 3456, v58
    v_lshl_add_u32 v84, v56, 4, v58
    v_add_u32 v56, 320, v1
    v_mul_u32_u24 v57, 4682, v56
    v_lshrrev_b32 v57, 16, v57
    v_mul_u32_u24 v58, 14, v57
    v_sub_u32 v56, v56, v58
    v_bfe_u32 v58, v57, 2, 2
    v_lshlrev_b32 v58, 3, v58
    v_and_or_b32 v58, v57, 3, v58
    v_lshrrev_b32 v57, 4, v57
    v_lshl_add_u32 v58, v57, 2, v58
    v_mul_u32_u24 v58, 3456, v58
    v_lshl_add_u32 v85, v56, 4, v58
    v_add_u32 v56, 384, v1
    v_mul_u32_u24 v57, 4682, v56
    v_lshrrev_b32 v57, 16, v57
    v_mul_u32_u24 v58, 14, v57
    v_sub_u32 v56, v56, v58
    v_bfe_u32 v58, v57, 2, 2
    v_lshlrev_b32 v58, 3, v58
    v_and_or_b32 v58, v57, 3, v58
    v_lshrrev_b32 v57, 4, v57
    v_lshl_add_u32 v58, v57, 2, v58
    v_mul_u32_u24 v58, 3456, v58
    v_lshl_add_u32 v86, v56, 4, v58
    s_lshr_b32 s53, s2, 5
    s_mul_i32 s53, s53, 0
    s_and_b32 s53, s53, 15
    s_mul_i32 s52, s53, 110592
    s_mul_i32 s53, s53, 7168
    s_lshl_b32 s55, s17, 5
    s_add_u32 s52, s52, s55
    s_waitcnt vmcnt(10)
    s_mov_b32 s54, 6
L_dma_a:
    s_add_u32 m0, s53, 0
    s_nop 0
    buffer_load_dwordx4 v80, s[8:11], s52 offen lds
    s_add_u32 m0, s53, 1024
    s_nop 0
    buffer_load_dwordx4 v81, s[8:11], s52 offen lds
    s_add_u32 m0, s53, 2048
    s_nop 0
    buffer_load_dwordx4 v82, s[8:11], s52 offen lds
    s_add_u32 m0, s53, 3072
    s_nop 0
    buffer_load_dwordx4 v83, s[8:11], s52 offen lds
    s_add_u32 m0, s53, 4096
    s_nop 0
    buffer_load_dwordx4 v84, s[8:11], s52 offen lds
    s_add_u32 m0, s53, 5120
    s_sub_u32 s54, s54, 1
    buffer_load_dwordx4 v85, s[8:11], s52 offen lds
    s_add_u32 m0, s53, 6144
    s_add_u32 s53, s53, 7168
    buffer_load_dwordx4 v86, s[8:11], s52 offen lds
    s_add_u32 s52, s52, 110592
    s_waitcnt vmcnt(14)
    s_cmp_lg_u32 s54, 0
    s_cbranch_scc1 L_dma_a
    v_lshrrev_b32 v56, 2, v1
    v_mul_u32_u24 v56, 160, v56
    v_and_b32 v57, 3, v1
    v_lshl_add_u32 v56, v57, 3, v56
    v_add_u32 v56, 129024, v56
    s_mul_i32 s48, s45, 54
    s_add_u32 s48, s48, s44
    s_mul_i32 s48, s48, 5120
    s_add_u32 s48, s48, 20971520
    s_cmp_lt_u32 s44, 54
    s_cselect_b32 s48, s48, 1073741824
    s_waitcnt vmcnt(42)
    ds_read_b64_tr_b16 v[96:97], v56 offset:0
    ds_read_b64_tr_b16 v[98:99], v56 offset:2560
    ds_read_b64_tr_b16 v[100:101], v56 offset:32
    ds_read_b64_tr_b16 v[102:103], v56 offset:2592
    ds_read_b64_tr_b16 v[104:105], v56 offset:64
    ds_read_b64_tr_b16 v[106:107], v56 offset:2624
    ds_read_b64_tr_b16 v[108:109], v56 offset:96
    ds_read_b64_tr_b16 v[110:111], v56 offset:2656
    ds_read_b64_tr_b16 v[112:113], v56 offset:128
    ds_read_b64_tr_b16 v[114:115], v56 offset:2688
    ds_read_b64_tr_b16 v[116:117], v56 offset:5120
    ds_read_b64_tr_b16 v[118:119], v56 offset:7680
    ds_read_b64_tr_b16 v[120:121], v56 offset:5152
    ds_read_b64_tr_b16 v[122:123], v56 offset:7712
    ds_read_b64_tr_b16 v[124:125], v56 offset:5184
    ds_read_b64_tr_b16 v[126:127], v56 offset:7744
    ds_read_b64_tr_b16 v[128:129], v56 offset:5216
    ds_read_b64_tr_b16 v[130:131], v56 offset:7776
    ds_read_b64_tr_b16 v[132:133], v56 offset:5248
    ds_read_b64_tr_b16 v[134:135], v56 offset:7808
    s_add_u32 s49, s48, 0
    s_waitcnt lgkmcnt(15)
    buffer_store_dwordx4 v[96:99], v12, s[28:31], s49 offen offset:0 sc1
    s_waitcnt lgkmcnt(15)
    buffer_store_dwordx4 v[100:103], v12, s[28:31], s49 offen offset:1024 sc1
    s_waitcnt lgkmcnt(14)
    buffer_store_dwordx4 v[104:107], v12, s[28:31], s49 offen offset:2048 sc1
    s_waitcnt lgkmcnt(12)
    buffer_store_dwordx4 v[108:111], v12, s[28:31], s49 offen offset:3072 sc1
    s_add_u32 s49, s48, 4096
    s_waitcnt lgkmcnt(10)
    buffer_store_dwordx4 v[112:115], v12, s[28:31], s49 offen offset:0 sc1
    s_add_u32 s49, s48, 276480
    s_waitcnt lgkmcnt(8)
    buffer_store_dwordx4 v[116:119], v12, s[28:31], s49 offen offset:0 sc1
    s_waitcnt lgkmcnt(6)
    buffer_store_dwordx4 v[120:123], v12, s[28:31], s49 offen offset:1024 sc1
    s_waitcnt lgkmcnt(4)
    buffer_store_dwordx4 v[124:127], v12, s[28:31], s49 offen offset:2048 sc1
    s_waitcnt lgkmcnt(2)
    buffer_store_dwordx4 v[128:131], v12, s[28:31], s49 offen offset:3072 sc1
    s_add_u32 s49, s48, 280576
    s_waitcnt lgkmcnt(0)
    buffer_store_dwordx4 v[132:135], v12, s[28:31], s49 offen offset:0 sc1
    v_mov_b32 v56, 139264
L_cw_l:
    ds_read_b32 v57, v56
    s_waitcnt lgkmcnt(0)
    v_cmp_gt_u32 vcc, 3, v57
    s_cbranch_vccnz L_cw_l
    s_lshr_b32 s58, s2, 3
    s_lshl_b32 s58, s58, 7
    s_and_b32 s55, s2, 7
    s_lshl_b32 s55, s55, 2
    s_add_u32 s58, s58, s55
    s_add_u32 s58, s58, 26607616
    s_mov_b32 s54, 6
L_dma_b:
    s_add_u32 m0, s53, 0
    s_nop 0
    buffer_load_dwordx4 v80, s[8:11], s52 offen lds
    s_add_u32 m0, s53, 1024
    s_nop 0
    buffer_load_dwordx4 v81, s[8:11], s52 offen lds
    s_add_u32 m0, s53, 2048
    s_nop 0
    buffer_load_dwordx4 v82, s[8:11], s52 offen lds
    s_add_u32 m0, s53, 3072
    s_nop 0
    buffer_load_dwordx4 v83, s[8:11], s52 offen lds
    s_add_u32 m0, s53, 4096
    s_nop 0
    buffer_load_dwordx4 v84, s[8:11], s52 offen lds
    s_add_u32 m0, s53, 5120
    s_sub_u32 s54, s54, 1
    buffer_load_dwordx4 v85, s[8:11], s52 offen lds
    s_add_u32 m0, s53, 6144
    s_add_u32 s53, s53, 7168
    buffer_load_dwordx4 v86, s[8:11], s52 offen lds
    s_add_u32 s52, s52, 110592
    s_cmp_lg_u32 s54, 0
    s_cbranch_scc1 L_dma_b
    s_waitcnt vmcnt(42)
    v_mov_b32 v16, s24
    v_mov_b32 v17, s25
    v_mov_b32 v18, 0
    s_mov_b64 exec, 1
    buffer_store_dword v16, v18, s[28:31], s58 offen sc1
    s_mov_b64 exec, -1
    s_bfe_u32 s69, s17, 0x10001
    s_mul_i32 s69, s69, 2
    s_sub_u32 s54, 4, s69
L_dma_b2:
    s_add_u32 m0, s53, 0
    s_nop 0
    buffer_load_dwordx4 v80, s[8:11], s52 offen lds
    s_add_u32 m0, s53, 1024
    s_nop 0
    buffer_load_dwordx4 v81, s[8:11], s52 offen lds
    s_add_u32 m0, s53, 2048
    s_nop 0
    buffer_load_dwordx4 v82, s[8:11], s52 offen lds
    s_add_u32 m0, s53, 3072
    s_nop 0
    buffer_load_dwordx4 v83, s[8:11], s52 offen lds
    s_add_u32 m0, s53, 4096
    s_nop 0
    buffer_load_dwordx4 v84, s[8:11], s52 offen lds
    s_add_u32 m0, s53, 5120
    s_sub_u32 s54, s54, 1
    buffer_load_dwordx4 v85, s[8:11], s52 offen lds
    s_add_u32 m0, s53, 6144
    s_add_u32 s53, s53, 7168
    buffer_load_dwordx4 v86, s[8:11], s52 offen lds
    s_add_u32 s52, s52, 110592
    s_cmp_lg_u32 s54, 0
    s_cbranch_scc1 L_dma_b2
    v_lshrrev_b32 v2, 1, v1
    v_lshlrev_b32 v2, 7, v2
    v_and_b32 v16, 1, v1
    v_lshl_add_u32 v2, v16, 4, v2
    s_and_b32 s40, s2, 0
    s_lshl_b32 s40, s40, 12
    v_add_u32 v2, s40, v2
    s_mov_b32 s40, 26542080
    v_lshrrev_b32 v7, 2, v1
    v_mul_u32_u24 v7, 224, v7
    v_and_b32 v8, 3, v1
    v_lshl_add_u32 v7, v8, 3, v7
    v_add_u32 v8, 64512, v7
    v_add_u32 v9, 129024, v7
    v_mov_b32 v16, 0x3f803f80
    v_mov_b32 v17, 0x3f803f80
    v_mov_b32 v18, 0x3f803f80
    v_mov_b32 v19, 0x3f803f80
    s_waitcnt vmcnt(0)
    s_barrier
    s_mov_b32 s59, 0
L_poll1:
L_poll1_go:
    buffer_load_dwordx4 v[88:91], v2, s[28:31], s40 offen sc1
    s_add_u32 s59, s59, 1
    s_cmp_gt_u32 s59, 200000
    s_cbranch_scc1 L_poll1_out
L_poll1_chk:
    s_waitcnt vmcnt(0)
    v_xor_b32 v88, s24, v88
    v_xor_b32 v89, s24, v89
    v_xor_b32 v90, s24, v90
    v_xor_b32 v91, s24, v91
    v_or_b32 v88, v88, v89
    v_or3_b32 v88, v88, v90, v91
    v_cmp_ne_u32 vcc, 0, v88
    s_cbranch_vccnz L_poll1
L_poll1_out:
    s_barrier
    ds_read_b64_tr_b16 v[48:49], v7 offset:0
    ds_read_b64_tr_b16 v[50:51], v7 offset:3584
    ds_read_b64_tr_b16 v[52:53], v7 offset:32
    ds_read_b64_tr_b16 v[54:55], v7 offset:3616
    ds_read_b64_tr_b16 v[56:57], v7 offset:64
    ds_read_b64_tr_b16 v[58:59], v7 offset:3648
    ds_read_b64_tr_b16 v[60:61], v7 offset:96
    ds_read_b64_tr_b16 v[62:63], v7 offset:3680
    ds_read_b64_tr_b16 v[64:65], v7 offset:128
    ds_read_b64_tr_b16 v[66:67], v7 offset:3712
    ds_read_b64_tr_b16 v[68:69], v7 offset:160
    ds_read_b64_tr_b16 v[70:71], v7 offset:3744
    s_waitcnt lgkmcnt(10)
    v_mfma_f32_16x16x32_bf16 v[20:23], v[48:51], v[16:19], 0
    ds_read_b64_tr_b16 v[72:73], v7 offset:192
    ds_read_b64_tr_b16 v[74:75], v7 offset:3776
    s_waitcnt lgkmcnt(10)
    v_mfma_f32_16x16x32_bf16 v[24:27], v[52:55], v[16:19], 0
    ds_read_b64_tr_b16 v[76:77], v7 offset:7168
    ds_read_b64_tr_b16 v[78:79], v7 offset:10752
    s_waitcnt lgkmcnt(10)
    v_mfma_f32_16x16x32_bf16 v[28:31], v[56:59], v[16:19], 0
    ds_read_b64_tr_b16 v[48:49], v7 offset:7200
    ds_read_b64_tr_b16 v[50:51], v7 offset:10784
    s_waitcnt lgkmcnt(10)
    v_mfma_f32_16x16x32_bf16 v[32:35], v[60:63], v[16:19], 0
    ds_read_b64_tr_b16 v[52:53], v7 offset:7232
    ds_read_b64_tr_b16 v[54:55], v7 offset:10816
    s_waitcnt lgkmcnt(10)
    v_mfma_f32_16x16x32_bf16 v[36:39], v[64:67], v[16:19], 0
    ds_read_b64_tr_b16 v[56:57], v7 offset:7264
    ds_read_b64_tr_b16 v[58:59], v7 offset:10848
    s_waitcnt lgkmcnt(10)
    v_mfma_f32_16x16x32_bf16 v[40:43], v[68:71], v[16:19], 0
    ds_read_b64_tr_b16 v[60:61], v7 offset:7296
    ds_read_b64_tr_b16 v[62:63], v7 offset:10880
    s_waitcnt lgkmcnt(10)
    v_mfma_f32_16x16x32_bf16 v[44:47], v[72:75], v[16:19], 0
    ds_read_b64_tr_b16 v[64:65], v7 offset:7328
    ds_read_b64_tr_b16 v[66:67], v7 offset:10912
    s_waitcnt lgkmcnt(10)
    v_mfma_f32_16x16x32_bf16 v[20:23], v[76:79], v[16:19], v[20:23]
    ds_read_b64_tr_b16 v[68:69], v7 offset:7360
    ds_read_b64_tr_b16 v[70:71], v7 offset:10944
    s_waitcnt lgkmcnt(10)
    v_mfma_f32_16x16x32_bf16 v[24:27], v[48:51], v[16:19], v[24:27]
    ds_read_b64_tr_b16 v[72:73], v7 offset:14336
    ds_read_b64_tr_b16 v[74:75], v7 offset:17920
    s_waitcnt lgkmcnt(10)
    v_mfma_f32_16x16x32_bf16 v[28:31], v[52:55], v[16:19], v[28:31]
    ds_read_b64_tr_b16 v[76:77], v7 offset:14368
    ds_read_b64_tr_b16 v[78:79], v7 offset:17952
    s_waitcnt lgkmcnt(10)
    v_mfma_f32_16x16x32_bf16 v[32:35], v[56:59], v[16:19], v[32:35]
    ds_read_b64_tr_b16 v[48:49], v7 offset:14400
    ds_read_b64_tr_b16 v[50:51], v7 offset:17984
    s_waitcnt lgkmcnt(10)
    v_mfma_f32_16x16x32_bf16 v[36:39], v[60:63], v[16:19], v[36:39]
    ds_read_b64_tr_b16 v[52:53], v7 offset:14432
    ds_read_b64_tr_b16 v[54:55], v7 offset:18016
    s_waitcnt lgkmcnt(10)
    v_mfma_f32_16x16x32_bf16 v[40:43], v[64:67], v[16:19], v[40:43]
    ds_read_b64_tr_b16 v[56:57], v7 offset:14464
    ds_read_b64_tr_b16 v[58:59], v7 offset:18048
    s_waitcnt lgkmcnt(10)
    v_mfma_f32_16x16x32_bf16 v[44:47], v[68:71], v[16:19], v[44:47]
    ds_read_b64_tr_b16 v[60:61], v7 offset:14496
    ds_read_b64_tr_b16 v[62:63], v7 offset:18080
    s_waitcnt lgkmcnt(10)
    v_mfma_f32_16x16x32_bf16 v[20:23], v[72:75], v[16:19], v[20:23]
    ds_read_b64_tr_b16 v[64:65], v7 offset:14528
    ds_read_b64_tr_b16 v[66:67], v7 offset:18112
    s_waitcnt lgkmcnt(10)
    v_mfma_f32_16x16x32_bf16 v[24:27], v[76:79], v[16:19], v[24:27]
    ds_read_b64_tr_b16 v[68:69], v7 offset:21504
    ds_read_b64_tr_b16 v[70:71], v7 offset:25088
    s_waitcnt lgkmcnt(10)
    v_mfma_f32_16x16x32_bf16 v[28:31], v[48:51], v[16:19], v[28:31]
    ds_read_b64_tr_b16 v[72:73], v7 offset:21536
    ds_read_b64_tr_b16 v[74:75], v7 offset:25120
    s_waitcnt lgkmcnt(10)
    v_mfma_f32_16x16x32_bf16 v[32:35], v[52:55], v[16:19], v[32:35]
    ds_read_b64_tr_b16 v[76:77], v7 offset:21568
    ds_read_b64_tr_b16 v[78:79], v7 offset:25152
    s_waitcnt lgkmcnt(10)
    v_mfma_f32_16x16x32_bf16 v[36:39], v[56:59], v[16:19], v[36:39]
    ds_read_b64_tr_b16 v[48:49], v7 offset:21600
    ds_read_b64_tr_b16 v[50:51], v7 offset:25184
    s_waitcnt lgkmcnt(10)
    v_mfma_f32_16x16x32_bf16 v[40:43], v[60:63], v[16:19], v[40:43]
    ds_read_b64_tr_b16 v[52:53], v7 offset:21632
    ds_read_b64_tr_b16 v[54:55], v7 offset:25216
    s_waitcnt lgkmcnt(10)
    v_mfma_f32_16x16x32_bf16 v[44:47], v[64:67], v[16:19], v[44:47]
    ds_read_b64_tr_b16 v[56:57], v7 offset:21664
    ds_read_b64_tr_b16 v[58:59], v7 offset:25248
    s_waitcnt lgkmcnt(10)
    v_mfma_f32_16x16x32_bf16 v[20:23], v[68:71], v[16:19], v[20:23]
    ds_read_b64_tr_b16 v[60:61], v7 offset:21696
    ds_read_b64_tr_b16 v[62:63], v7 offset:25280
    s_waitcnt lgkmcnt(10)
    v_mfma_f32_16x16x32_bf16 v[24:27], v[72:75], v[16:19], v[24:27]
    s_waitcnt lgkmcnt(8)
    v_mfma_f32_16x16x32_bf16 v[28:31], v[76:79], v[16:19], v[28:31]
    s_waitcnt lgkmcnt(6)
    v_mfma_f32_16x16x32_bf16 v[32:35], v[48:51], v[16:19], v[32:35]
    s_waitcnt lgkmcnt(4)
    v_mfma_f32_16x16x32_bf16 v[36:39], v[52:55], v[16:19], v[36:39]
    s_waitcnt lgkmcnt(2)
    v_mfma_f32_16x16x32_bf16 v[40:43], v[56:59], v[16:19], v[40:43]
    s_waitcnt lgkmcnt(0)
    v_mfma_f32_16x16x32_bf16 v[44:47], v[60:63], v[16:19], v[44:47]
    s_add_u32 s54, 4, s69
L_dma_c:
    s_add_u32 m0, s53, 0
    s_nop 0
    buffer_load_dwordx4 v80, s[8:11], s52 offen lds
    s_add_u32 m0, s53, 1024
    s_nop 0
    buffer_load_dwordx4 v81, s[8:11], s52 offen lds
    s_add_u32 m0, s53, 2048
    s_nop 0
    buffer_load_dwordx4 v82, s[8:11], s52 offen lds
    s_add_u32 m0, s53, 3072
    s_nop 0
    buffer_load_dwordx4 v83, s[8:11], s52 offen lds
    s_add_u32 m0, s53, 4096
    s_nop 0
    buffer_load_dwordx4 v84, s[8:11], s52 offen lds
    s_add_u32 m0, s53, 5120
    s_sub_u32 s54, s54, 1
    buffer_load_dwordx4 v85, s[8:11], s52 offen lds
    s_add_u32 m0, s53, 6144
    s_add_u32 s53, s53, 7168
    buffer_load_dwordx4 v86, s[8:11], s52 offen lds
    s_add_u32 s52, s52, 110592
    s_cmp_lg_u32 s54, 0
    s_cbranch_scc1 L_dma_c
    s_mov_b32 s40, 26607616
    buffer_load_dwordx4 v[100:103], v2, s[28:31], s40 offen sc1
    v_lshrrev_b32 v5, 4, v1
    v_lshlrev_b32 v5, 4, v5
    v_add_u32 v5, 155648, v5
    s_mov_b32 exec_lo, 0x10001
    s_mov_b32 exec_hi, 0x10001
    ds_write_b128 v5, v[20:23] offset:0
    ds_write_b128 v5, v[24:27] offset:64
    ds_write_b128 v5, v[28:31] offset:128
    ds_write_b128 v5, v[32:35] offset:192
    ds_write_b128 v5, v[36:39] offset:256
    ds_write_b128 v5, v[40:43] offset:320
    ds_write_b128 v5, v[44:47] offset:384
    s_mov_b64 exec, -1
    s_mov_b32 s59, 0
    s_branch L_poll1b_chk
L_poll1b:
L_poll1b_go:
    buffer_load_dwordx4 v[100:103], v2, s[28:31], s40 offen sc1
    s_add_u32 s59, s59, 1
    s_cmp_gt_u32 s59, 200000
    s_cbranch_scc1 L_poll1b_out
L_poll1b_chk:
    s_waitcnt vmcnt(0)
    v_xor_b32 v100, s24, v100
    v_xor_b32 v101, s24, v101
    v_xor_b32 v102, s24, v102
    v_xor_b32 v103, s24, v103
    v_or_b32 v100, v100, v101
    v_or3_b32 v100, v100, v102, v103
    v_cmp_ne_u32 vcc, 0, v100
    s_cbranch_vccnz L_poll1b
L_poll1b_out:
    s_waitcnt lgkmcnt(0)
L_join:
    s_lshr_b32 s40, s23, 2
    s_mul_i32 s40, s40, 2560
    s_add_u32 s40, s40, 26247168
    v_min_u32 v2, 19, v1
    v_lshlrev_b32 v2, 7, v2
    s_mul_i32 s44, s23, 20480
    s_add_u32 s44, s44, 4194304
    s_add_u32 s45, s44, 20480
    v_lshrrev_b32 v4, 4, v1
    v_lshlrev_b32 v5, 4, v4
    v_add_u32 v5, 155648, v5
    v_mul_u32_u24 v4, 640, v4
    v_and_b32 v3, 15, v1
    v_lshl_add_u32 v14, v3, 3, v4
    s_mul_i32 s46, s23, 2560
    s_add_u32 s46, s46, 8388608
    s_lshl_b32 s41, s3, 6
    v_add_u32 v31, s41, v5
    s_lshl_b32 s41, s3, 5
    v_lshrrev_b32 v7, 2, v1
    v_mul_u32_u24 v7, 224, v7
    v_and_b32 v8, 3, v1
    v_lshl_add_u32 v7, v8, 3, v7
    v_add_u32 v8, 64512, v7
    v_add_u32 v9, 129024, v7
    v_add_u32 v28, s41, v7
    v_add_u32 v29, s41, v8
    v_add_u32 v30, s41, v9
    v_mov_b32 v16, 0x3f803f80
    v_mov_b32 v17, 0x3f803f80
    v_mov_b32 v18, 0x3f803f80
    v_mov_b32 v19, 0x3f803f80
    v_bfe_u32 v6, v1, 4, 1
    v_mul_u32_u24 v6, 55296, v6
    v_lshrrev_b32 v4, 5, v1
    v_lshl_add_u32 v6, v4, 8, v6
    v_and_b32 v4, 15, v1
    v_lshl_add_u32 v6, v4, 4, v6
    s_barrier
    buffer_load_dwordx4 a[0:3], v12, s[28:31], s21 offen offset:0 sc1
    buffer_load_dwordx4 a[4:7], v12, s[28:31], s21 offen offset:1024 sc1
    buffer_load_dwordx4 a[8:11], v12, s[28:31], s21 offen offset:2048 sc1
    buffer_load_dwordx4 a[12:15], v12, s[28:31], s21 offen offset:3072 sc1
    s_add_u32 s21, s21, 4096
    buffer_load_dwordx4 a[16:19], v12, s[28:31], s21 offen offset:0 sc1
    ds_read_b128 v[20:23], v31
    ds_read_b128 v[24:27], v31 offset:256
    ds_read_b64_tr_b16 v[32:33], v28 offset:28672
    ds_read_b64_tr_b16 v[34:35], v28 offset:32256
    ds_read_b64_tr_b16 v[36:37], v28 offset:28800
    ds_read_b64_tr_b16 v[38:39], v28 offset:32384
    ds_read_b64_tr_b16 v[40:41], v28 offset:35840
    ds_read_b64_tr_b16 v[42:43], v28 offset:39424
    ds_read_b64_tr_b16 v[44:45], v28 offset:35968
    ds_read_b64_tr_b16 v[46:47], v28 offset:39552
    ds_read_b64_tr_b16 v[48:49], v28 offset:43008
    ds_read_b64_tr_b16 v[50:51], v28 offset:46592
    ds_read_b64_tr_b16 v[52:53], v28 offset:43136
    ds_read_b64_tr_b16 v[54:55], v28 offset:46720
    s_waitcnt lgkmcnt(10)
    v_mfma_f32_16x16x32_bf16 v[20:23], v[32:35], v[16:19], v[20:23]
    ds_read_b64_tr_b16 v[56:57], v28 offset:50176
    ds_read_b64_tr_b16 v[58:59], v28 offset:53760
    buffer_load_dwordx4 a[20:23], v12, s[28:31], s21 offen offset:1024 sc1
    s_waitcnt lgkmcnt(10)
    v_mfma_f32_16x16x32_bf16 v[24:27], v[36:39], v[16:19], v[24:27]
    ds_read_b64_tr_b16 v[60:61], v28 offset:50304
    ds_read_b64_tr_b16 v[62:63], v28 offset:53888
    s_waitcnt lgkmcnt(10)
    v_mfma_f32_16x16x32_bf16 v[20:23], v[40:43], v[16:19], v[20:23]
    ds_read_b64_tr_b16 v[32:33], v28 offset:57344
    ds_read_b64_tr_b16 v[34:35], v28 offset:60928
    s_waitcnt lgkmcnt(10)
    v_mfma_f32_16x16x32_bf16 v[24:27], v[44:47], v[16:19], v[24:27]
    ds_read_b64_tr_b16 v[36:37], v28 offset:57472
    ds_read_b64_tr_b16 v[38:39], v28 offset:61056
    buffer_load_dwordx4 a[24:27], v12, s[28:31], s21 offen offset:2048 sc1
    s_waitcnt lgkmcnt(10)
    v_mfma_f32_16x16x32_bf16 v[20:23], v[48:51], v[16:19], v[20:23]
    ds_read_b64_tr_b16 v[40:41], v29 offset:0
    ds_read_b64_tr_b16 v[42:43], v29 offset:3584
    s_waitcnt lgkmcnt(10)
    v_mfma_f32_16x16x32_bf16 v[24:27], v[52:55], v[16:19], v[24:27]
    ds_read_b64_tr_b16 v[44:45], v29 offset:128
    ds_read_b64_tr_b16 v[46:47], v29 offset:3712
    s_waitcnt lgkmcnt(10)
    v_mfma_f32_16x16x32_bf16 v[20:23], v[56:59], v[16:19], v[20:23]
    ds_read_b64_tr_b16 v[48:49], v29 offset:7168
    ds_read_b64_tr_b16 v[50:51], v29 offset:10752
    buffer_load_dwordx4 a[28:31], v12, s[28:31], s21 offen offset:3072 sc1
    s_waitcnt lgkmcnt(10)
    v_mfma_f32_16x16x32_bf16 v[24:27], v[60:63], v[16:19], v[24:27]
    ds_read_b64_tr_b16 v[52:53], v29 offset:7296
    ds_read_b64_tr_b16 v[54:55], v29 offset:10880
    s_waitcnt lgkmcnt(10)
    v_mfma_f32_16x16x32_bf16 v[20:23], v[32:35], v[16:19], v[20:23]
    ds_read_b64_tr_b16 v[56:57], v29 offset:14336
    ds_read_b64_tr_b16 v[58:59], v29 offset:17920
    s_waitcnt lgkmcnt(10)
    v_mfma_f32_16x16x32_bf16 v[24:27], v[36:39], v[16:19], v[24:27]
    ds_read_b64_tr_b16 v[60:61], v29 offset:14464
    ds_read_b64_tr_b16 v[62:63], v29 offset:18048
    s_add_u32 s21, s21, 4096
    buffer_load_dwordx4 a[32:35], v12, s[28:31], s21 offen offset:0 sc1
    s_waitcnt lgkmcnt(10)
    v_mfma_f32_16x16x32_bf16 v[20:23], v[40:43], v[16:19], v[20:23]
    ds_read_b64_tr_b16 v[32:33], v29 offset:21504
    ds_read_b64_tr_b16 v[34:35], v29 offset:25088
    s_waitcnt lgkmcnt(10)
    v_mfma_f32_16x16x32_bf16 v[24:27], v[44:47], v[16:19], v[24:27]
    ds_read_b64_tr_b16 v[36:37], v29 offset:21632
    ds_read_b64_tr_b16 v[38:39], v29 offset:25216
    s_waitcnt lgkmcnt(10)
    v_mfma_f32_16x16x32_bf16 v[20:23], v[48:51], v[16:19], v[20:23]
    ds_read_b64_tr_b16 v[40:41], v29 offset:28672
    ds_read_b64_tr_b16 v[42:43], v29 offset:32256
    buffer_load_dwordx4 a[36:39], v12, s[28:31], s21 offen offset:1024 sc1
    s_waitcnt lgkmcnt(10)
    v_mfma_f32_16x16x32_bf16 v[24:27], v[52:55], v[16:19], v[24:27]
    ds_read_b64_tr_b16 v[44:45], v29 offset:28800
    ds_read_b64_tr_b16 v[46:47], v29 offset:32384
    s_waitcnt lgkmcnt(10)
    v_mfma_f32_16x16x32_bf16 v[20:23], v[56:59], v[16:19], v[20:23]
    ds_read_b64_tr_b16 v[48:49], v29 offset:35840
    ds_read_b64_tr_b16 v[50:51], v29 offset:39424
    s_waitcnt lgkmcnt(10)
    v_mfma_f32_16x16x32_bf16 v[24:27], v[60:63], v[16:19], v[24:27]
    ds_read_b64_tr_b16 v[52:53], v29 offset:35968
    ds_read_b64_tr_b16 v[54:55], v29 offset:39552
    buffer_load_dwordx4 a[40:43], v12, s[28:31], s21 offen offset:2048 sc1
    s_waitcnt lgkmcnt(10)
    v_mfma_f32_16x16x32_bf16 v[20:23], v[32:35], v[16:19], v[20:23]
    ds_read_b64_tr_b16 v[56:57], v29 offset:43008
    ds_read_b64_tr_b16 v[58:59], v29 offset:46592
    s_waitcnt lgkmcnt(10)
    v_mfma_f32_16x16x32_bf16 v[24:27], v[36:39], v[16:19], v[24:27]
    ds_read_b64_tr_b16 v[60:61], v29 offset:43136
    ds_read_b64_tr_b16 v[62:63], v29 offset:46720
    s_waitcnt lgkmcnt(10)
    v_mfma_f32_16x16x32_bf16 v[20:23], v[40:43], v[16:19], v[20:23]
    ds_read_b64_tr_b16 v[32:33], v29 offset:50176
    ds_read_b64_tr_b16 v[34:35], v29 offset:53760
    buffer_load_dwordx4 a[44:47], v12, s[28:31], s21 offen offset:3072 sc1
    s_waitcnt lgkmcnt(10)
    v_mfma_f32_16x16x32_bf16 v[24:27], v[44:47], v[16:19], v[24:27]
    ds_read_b64_tr_b16 v[36:37], v29 offset:50304
    ds_read_b64_tr_b16 v[38:39], v29 offset:53888
    s_waitcnt lgkmcnt(10)
    v_mfma_f32_16x16x32_bf16 v[20:23], v[48:51], v[16:19], v[20:23]
    ds_read_b64_tr_b16 v[40:41], v29 offset:57344
    ds_read_b64_tr_b16 v[42:43], v29 offset:60928
    s_waitcnt lgkmcnt(10)
    v_mfma_f32_16x16x32_bf16 v[24:27], v[52:55], v[16:19], v[24:27]
    ds_read_b64_tr_b16 v[44:45], v29 offset:57472
    ds_read_b64_tr_b16 v[46:47], v29 offset:61056
    s_add_u32 s21, s21, 4096
    buffer_load_dwordx4 a[48:51], v12, s[28:31], s21 offen offset:0 sc1
    s_waitcnt lgkmcnt(10)
    v_mfma_f32_16x16x32_bf16 v[20:23], v[56:59], v[16:19], v[20:23]
    ds_read_b64_tr_b16 v[48:49], v30 offset:0
    ds_read_b64_tr_b16 v[50:51], v30 offset:3584
    s_waitcnt lgkmcnt(10)
    v_mfma_f32_16x16x32_bf16 v[24:27], v[60:63], v[16:19], v[24:27]
    ds_read_b64_tr_b16 v[52:53], v30 offset:128
    ds_read_b64_tr_b16 v[54:55], v30 offset:3712
    s_waitcnt lgkmcnt(10)
    v_mfma_f32_16x16x32_bf16 v[20:23], v[32:35], v[16:19], v[20:23]
    ds_read_b64_tr_b16 v[56:57], v30 offset:7168
    ds_read_b64_tr_b16 v[58:59], v30 offset:10752
    buffer_load_dwordx4 a[52:55], v12, s[28:31], s21 offen offset:1024 sc1
    s_waitcnt lgkmcnt(10)
    v_mfma_f32_16x16x32_bf16 v[24:27], v[36:39], v[16:19], v[24:27]
    ds_read_b64_tr_b16 v[60:61], v30 offset:7296
    ds_read_b64_tr_b16 v[62:63], v30 offset:10880
    s_waitcnt lgkmcnt(10)
    v_mfma_f32_16x16x32_bf16 v[20:23], v[40:43], v[16:19], v[20:23]
    s_waitcnt lgkmcnt(8)
    v_mfma_f32_16x16x32_bf16 v[24:27], v[44:47], v[16:19], v[24:27]
    buffer_load_dwordx4 a[56:59], v12, s[28:31], s21 offen offset:2048 sc1
    s_waitcnt lgkmcnt(6)
    v_mfma_f32_16x16x32_bf16 v[20:23], v[48:51], v[16:19], v[20:23]
    s_waitcnt lgkmcnt(4)
    v_mfma_f32_16x16x32_bf16 v[24:27], v[52:55], v[16:19], v[24:27]
    s_waitcnt lgkmcnt(2)
    v_mfma_f32_16x16x32_bf16 v[20:23], v[56:59], v[16:19], v[20:23]
    buffer_load_dwordx4 a[60:63], v12, s[28:31], s21 offen offset:3072 sc1
    s_waitcnt lgkmcnt(0)
    v_mfma_f32_16x16x32_bf16 v[24:27], v[60:63], v[16:19], v[24:27]
    s_mov_b32 exec_lo, 0x10001
    s_mov_b32 exec_hi, 0x10001
    s_nop 2
    ds_write_b128 v31, v[20:23]
    s_nop 1
    ds_write_b128 v31, v[24:27] offset:256
    s_mov_b64 exec, -1
    s_add_u32 s21, s21, 4096
    buffer_load_dwordx4 a[64:67], v12, s[28:31], s21 offen offset:0 sc1
    buffer_load_dwordx4 a[68:71], v12, s[28:31], s21 offen offset:1024 sc1
    buffer_load_dwordx4 a[72:75], v12, s[28:31], s21 offen offset:2048 sc1
    buffer_load_dwordx4 a[76:79], v12, s[28:31], s21 offen offset:3072 sc1
    s_add_u32 s21, s21, 4096
    buffer_load_dwordx4 a[80:83], v12, s[28:31], s21 offen offset:0 sc1
    buffer_load_dwordx4 a[84:87], v12, s[28:31], s21 offen offset:1024 sc1
    buffer_load_dwordx2 v[10:11], v2, s[28:31], s40 offen sc1
    s_waitcnt lgkmcnt(0)
    s_barrier
    ds_read_b64_tr_b16 v[72:73], v7 offset:0
    ds_read_b64_tr_b16 v[74:75], v7 offset:3584
    ds_read_b64_tr_b16 v[76:77], v7 offset:32
    ds_read_b64_tr_b16 v[78:79], v7 offset:3616
    ds_read_b64_tr_b16 v[80:81], v7 offset:64
    ds_read_b64_tr_b16 v[82:83], v7 offset:3648
    ds_read_b64_tr_b16 v[84:85], v7 offset:96
    ds_read_b64_tr_b16 v[86:87], v7 offset:3680
    ds_read_b64_tr_b16 v[88:89], v7 offset:128
    ds_read_b64_tr_b16 v[90:91], v7 offset:3712
    ds_read_b64_tr_b16 v[92:93], v7 offset:160
    ds_read_b64_tr_b16 v[94:95], v7 offset:3744
    s_mov_b32 s59, 0
    s_branch L_poll2_chk
L_poll2:
L_poll2_go:
    buffer_load_dwordx2 v[10:11], v2, s[28:31], s40 offen sc1
    s_add_u32 s59, s59, 1
    s_cmp_gt_u32 s59, 200000
    s_cbranch_scc1 L_poll2_out
L_poll2_chk:
    s_waitcnt vmcnt(0)
    v_cmp_ne_u64 vcc, s[24:25], v[10:11]
    s_cbranch_vccnz L_poll2
L_poll2_out:
    buffer_load_dwordx4 v[104:107], v12, s[28:31], s44 offen offset:0 sc1
    buffer_load_dwordx4 v[108:111], v12, s[28:31], s45 offen offset:0 sc1
    buffer_load_dwordx4 v[112:115], v12, s[28:31], s44 offen offset:1024 sc1
    buffer_load_dwordx4 v[116:119], v12, s[28:31], s45 offen offset:1024 sc1
    buffer_load_dwordx4 v[120:123], v12, s[28:31], s44 offen offset:2048 sc1
    buffer_load_dwordx4 v[124:127], v12, s[28:31], s45 offen offset:2048 sc1
    buffer_load_dwordx4 v[128:131], v12, s[28:31], s44 offen offset:3072 sc1
    buffer_load_dwordx4 v[132:135], v12, s[28:31], s45 offen offset:3072 sc1
    s_add_u32 s44, s44, 4096
    buffer_load_dwordx4 v[136:139], v12, s[28:31], s44 offen offset:0 sc1
    s_add_u32 s45, s45, 4096
    buffer_load_dwordx4 v[140:143], v12, s[28:31], s45 offen offset:0 sc1
    s_waitcnt vmcnt(8)
    s_waitcnt lgkmcnt(8)
    v_mfma_f32_16x16x32_bf16 v[16:19], v[72:75], v[104:107], 0
    ds_read_b64_tr_b16 v[96:97], v7 offset:192
    buffer_load_dwordx4 v[144:147], v12, s[28:31], s44 offen offset:1024 sc1
    v_mfma_f32_16x16x32_bf16 v[20:23], v[72:75], v[108:111], 0
    ds_read_b64_tr_b16 v[98:99], v7 offset:3776
    ds_read_b128 v[184:187], v5 offset:0
    v_mfma_f32_16x16x32_bf16 v[24:27], v[76:79], v[104:107], 0
    ds_read_b64_tr_b16 v[100:101], v7 offset:7168
    ds_read_b128 v[188:191], v5 offset:64
    v_mfma_f32_16x16x32_bf16 v[28:31], v[76:79], v[108:111], 0
    ds_read_b64_tr_b16 v[102:103], v7 offset:10752
    s_waitcnt lgkmcnt(10)
    v_mfma_f32_16x16x32_bf16 v[32:35], v[80:83], v[104:107], 0
    ds_read_b64_tr_b16 v[72:73], v7 offset:7200
    buffer_load_dwordx4 v[148:151], v12, s[28:31], s45 offen offset:1024 sc1
    v_mfma_f32_16x16x32_bf16 v[36:39], v[80:83], v[108:111], 0
    ds_read_b64_tr_b16 v[74:75], v7 offset:10784
    ds_read_b128 v[192:195], v5 offset:128
    v_mfma_f32_16x16x32_bf16 v[40:43], v[84:87], v[104:107], 0
    ds_read_b64_tr_b16 v[76:77], v7 offset:7232
    ds_read_b128 v[196:199], v5 offset:192
    v_mfma_f32_16x16x32_bf16 v[44:47], v[84:87], v[108:111], 0
    ds_read_b64_tr_b16 v[78:79], v7 offset:10816
    s_waitcnt lgkmcnt(12)
    v_mfma_f32_16x16x32_bf16 v[48:51], v[88:91], v[104:107], 0
    ds_read_b64_tr_b16 v[80:81], v7 offset:7264
    ds_read_b128 v[200:203], v5 offset:256
    v_mfma_f32_16x16x32_bf16 v[52:55], v[88:91], v[108:111], 0
    ds_read_b64_tr_b16 v[82:83], v7 offset:10848
    ds_read_b128 v[204:207], v5 offset:320
    v_mfma_f32_16x16x32_bf16 v[56:59], v[92:95], v[104:107], 0
    ds_read_b64_tr_b16 v[84:85], v7 offset:7296
    ds_read_b128 v[208:211], v5 offset:384
    v_mfma_f32_16x16x32_bf16 v[60:63], v[92:95], v[108:111], 0
    ds_read_b64_tr_b16 v[86:87], v7 offset:10880
    s_waitcnt lgkmcnt(13)
    v_mfma_f32_16x16x32_bf16 v[64:67], v[96:99], v[104:107], 0
    ds_read_b64_tr_b16 v[88:89], v7 offset:7328
    s_waitcnt vmcnt(8)
    v_mfma_f32_16x16x32_bf16 v[68:71], v[96:99], v[108:111], 0
    ds_read_b64_tr_b16 v[90:91], v7 offset:10912
    buffer_load_dword v212, v14, s[28:31], s46 offen offset:0 sc1
    v_mfma_f32_16x16x32_bf16 v[16:19], v[100:103], v[112:115], v[16:19]
    ds_read_b64_tr_b16 v[92:93], v7 offset:7360
    buffer_load_dwordx4 v[152:155], v12, s[28:31], s44 offen offset:2048 sc1
    v_mfma_f32_16x16x32_bf16 v[20:23], v[100:103], v[116:119], v[20:23]
    ds_read_b64_tr_b16 v[94:95], v7 offset:10944
    s_waitcnt lgkmcnt(11)
    v_mfma_f32_16x16x32_bf16 v[24:27], v[72:75], v[112:115], v[24:27]
    ds_read_b64_tr_b16 v[96:97], v7 offset:14336
    buffer_load_dword v213, v14, s[28:31], s46 offen offset:128 sc1
    v_mfma_f32_16x16x32_bf16 v[28:31], v[72:75], v[116:119], v[28:31]
    ds_read_b64_tr_b16 v[98:99], v7 offset:17920
    buffer_load_dword v214, v14, s[28:31], s46 offen offset:256 sc1
    v_mfma_f32_16x16x32_bf16 v[32:35], v[76:79], v[112:115], v[32:35]
    ds_read_b64_tr_b16 v[100:101], v7 offset:14368
    buffer_load_dwordx4 v[156:159], v12, s[28:31], s45 offen offset:2048 sc1
    v_mfma_f32_16x16x32_bf16 v[36:39], v[76:79], v[116:119], v[36:39]
    ds_read_b64_tr_b16 v[102:103], v7 offset:17952
    s_waitcnt lgkmcnt(8)
    v_mfma_f32_16x16x32_bf16 v[40:43], v[80:83], v[112:115], v[40:43]
    ds_read_b64_tr_b16 v[72:73], v7 offset:14400
    buffer_load_dword v215, v14, s[28:31], s46 offen offset:384 sc1
    v_mfma_f32_16x16x32_bf16 v[44:47], v[80:83], v[116:119], v[44:47]
    ds_read_b64_tr_b16 v[74:75], v7 offset:17984
    buffer_load_dword v216, v14, s[28:31], s46 offen offset:512 sc1
    v_mfma_f32_16x16x32_bf16 v[48:51], v[84:87], v[112:115], v[48:51]
    ds_read_b64_tr_b16 v[76:77], v7 offset:14432
    buffer_load_dword v217, v14, s[28:31], s46 offen offset:2560 sc1
    v_mfma_f32_16x16x32_bf16 v[52:55], v[84:87], v[116:119], v[52:55]
    ds_read_b64_tr_b16 v[78:79], v7 offset:18016
    s_waitcnt lgkmcnt(8)
    v_mfma_f32_16x16x32_bf16 v[56:59], v[88:91], v[112:115], v[56:59]
    ds_read_b64_tr_b16 v[80:81], v7 offset:14464
    buffer_load_dword v218, v14, s[28:31], s46 offen offset:2688 sc1
    v_mfma_f32_16x16x32_bf16 v[60:63], v[88:91], v[116:119], v[60:63]
    ds_read_b64_tr_b16 v[82:83], v7 offset:18048
    buffer_load_dword v219, v14, s[28:31], s46 offen offset:2816 sc1
    v_mfma_f32_16x16x32_bf16 v[64:67], v[92:95], v[112:115], v[64:67]
    ds_read_b64_tr_b16 v[84:85], v7 offset:14496
    s_waitcnt vmcnt(16)
    v_mfma_f32_16x16x32_bf16 v[68:71], v[92:95], v[116:119], v[68:71]
    ds_read_b64_tr_b16 v[86:87], v7 offset:18080
    s_waitcnt lgkmcnt(8)
    v_mfma_f32_16x16x32_bf16 v[16:19], v[96:99], v[120:123], v[16:19]
    ds_read_b64_tr_b16 v[88:89], v7 offset:14528
    buffer_load_dwordx4 v[160:163], v12, s[28:31], s44 offen offset:3072 sc1
    v_mfma_f32_16x16x32_bf16 v[20:23], v[96:99], v[124:127], v[20:23]
    ds_read_b64_tr_b16 v[90:91], v7 offset:18112
    buffer_load_dword v220, v14, s[28:31], s46 offen offset:2944 sc1
    v_mfma_f32_16x16x32_bf16 v[24:27], v[100:103], v[120:123], v[24:27]
    ds_read_b64_tr_b16 v[92:93], v7 offset:21504
    buffer_load_dword v221, v14, s[28:31], s46 offen offset:3072 sc1
    v_mfma_f32_16x16x32_bf16 v[28:31], v[100:103], v[124:127], v[28:31]
    ds_read_b64_tr_b16 v[94:95], v7 offset:25088
    s_waitcnt lgkmcnt(8)
    v_mfma_f32_16x16x32_bf16 v[32:35], v[72:75], v[120:123], v[32:35]
    ds_read_b64_tr_b16 v[96:97], v7 offset:21536
    buffer_load_dwordx4 v[164:167], v12, s[28:31], s45 offen offset:3072 sc1
    v_mfma_f32_16x16x32_bf16 v[36:39], v[72:75], v[124:127], v[36:39]
    ds_read_b64_tr_b16 v[98:99], v7 offset:25120
    v_mfma_f32_16x16x32_bf16 v[40:43], v[76:79], v[120:123], v[40:43]
    ds_read_b64_tr_b16 v[100:101], v7 offset:21568
    v_mfma_f32_16x16x32_bf16 v[44:47], v[76:79], v[124:127], v[44:47]
    ds_read_b64_tr_b16 v[102:103], v7 offset:25152
    s_waitcnt lgkmcnt(8)
    v_mfma_f32_16x16x32_bf16 v[48:51], v[80:83], v[120:123], v[48:51]
    ds_read_b64_tr_b16 v[72:73], v7 offset:21600
    v_mfma_f32_16x16x32_bf16 v[52:55], v[80:83], v[124:127], v[52:55]
    ds_read_b64_tr_b16 v[74:75], v7 offset:25184
    v_mfma_f32_16x16x32_bf16 v[56:59], v[84:87], v[120:123], v[56:59]
    ds_read_b64_tr_b16 v[76:77], v7 offset:21632
    v_mfma_f32_16x16x32_bf16 v[60:63], v[84:87], v[124:127], v[60:63]
    ds_read_b64_tr_b16 v[78:79], v7 offset:25216
    s_waitcnt lgkmcnt(8)
    v_mfma_f32_16x16x32_bf16 v[64:67], v[88:91], v[120:123], v[64:67]
    ds_read_b64_tr_b16 v[80:81], v7 offset:21664
    s_waitcnt vmcnt(18)
    v_mfma_f32_16x16x32_bf16 v[68:71], v[88:91], v[124:127], v[68:71]
    ds_read_b64_tr_b16 v[82:83], v7 offset:25248
    v_mfma_f32_16x16x32_bf16 v[16:19], v[92:95], v[128:131], v[16:19]
    ds_read_b64_tr_b16 v[84:85], v7 offset:21696
    s_add_u32 s44, s44, 4096
    buffer_load_dwordx4 v[168:171], v12, s[28:31], s44 offen offset:0 sc1
    v_mfma_f32_16x16x32_bf16 v[20:23], v[92:95], v[132:135], v[20:23]
    ds_read_b64_tr_b16 v[86:87], v7 offset:25280
    s_waitcnt lgkmcnt(8)
    v_mfma_f32_16x16x32_bf16 v[24:27], v[96:99], v[128:131], v[24:27]
    ds_read_b64_tr_b16 v[88:89], v7 offset:28672
    v_mfma_f32_16x16x32_bf16 v[28:31], v[96:99], v[132:135], v[28:31]
    ds_read_b64_tr_b16 v[90:91], v7 offset:32256
    v_mfma_f32_16x16x32_bf16 v[32:35], v[100:103], v[128:131], v[32:35]
    ds_read_b64_tr_b16 v[92:93], v7 offset:28704
    s_add_u32 s45, s45, 4096
    buffer_load_dwordx4 v[172:175], v12, s[28:31], s45 offen offset:0 sc1
    v_mfma_f32_16x16x32_bf16 v[36:39], v[100:103], v[132:135], v[36:39]
    ds_read_b64_tr_b16 v[94:95], v7 offset:32288
    s_waitcnt lgkmcnt(8)
    v_mfma_f32_16x16x32_bf16 v[40:43], v[72:75], v[128:131], v[40:43]
    ds_read_b64_tr_b16 v[96:97], v7 offset:28736
    v_mfma_f32_16x16x32_bf16 v[44:47], v[72:75], v[132:135], v[44:47]
    ds_read_b64_tr_b16 v[98:99], v7 offset:32320
    v_mfma_f32_16x16x32_bf16 v[48:51], v[76:79], v[128:131], v[48:51]
    ds_read_b64_tr_b16 v[100:101], v7 offset:28768
    v_mfma_f32_16x16x32_bf16 v[52:55], v[76:79], v[132:135], v[52:55]
    ds_read_b64_tr_b16 v[102:103], v7 offset:32352
    s_waitcnt lgkmcnt(8)
    v_mfma_f32_16x16x32_bf16 v[56:59], v[80:83], v[128:131], v[56:59]
    ds_read_b64_tr_b16 v[72:73], v7 offset:28800
    v_mfma_f32_16x16x32_bf16 v[60:63], v[80:83], v[132:135], v[60:63]
    ds_read_b64_tr_b16 v[74:75], v7 offset:32384
    v_mfma_f32_16x16x32_bf16 v[64:67], v[84:87], v[128:131], v[64:67]
    ds_read_b64_tr_b16 v[76:77], v7 offset:28832
    s_waitcnt vmcnt(18)
    v_mfma_f32_16x16x32_bf16 v[68:71], v[84:87], v[132:135], v[68:71]
    ds_read_b64_tr_b16 v[78:79], v7 offset:32416
    s_waitcnt lgkmcnt(8)
    v_mfma_f32_16x16x32_bf16 v[16:19], v[88:91], v[136:139], v[16:19]
    ds_read_b64_tr_b16 v[80:81], v7 offset:28864
    buffer_load_dwordx4 v[176:179], v12, s[28:31], s44 offen offset:1024 sc1
    v_mfma_f32_16x16x32_bf16 v[20:23], v[88:91], v[140:143], v[20:23]
    ds_read_b64_tr_b16 v[82:83], v7 offset:32448
    v_mfma_f32_16x16x32_bf16 v[24:27], v[92:95], v[136:139], v[24:27]
    ds_read_b64_tr_b16 v[84:85], v7 offset:35840
    v_mfma_f32_16x16x32_bf16 v[28:31], v[92:95], v[140:143], v[28:31]
    ds_read_b64_tr_b16 v[86:87], v7 offset:39424
    s_waitcnt lgkmcnt(8)
    v_mfma_f32_16x16x32_bf16 v[32:35], v[96:99], v[136:139], v[32:35]
    ds_read_b64_tr_b16 v[88:89], v7 offset:35872
    buffer_load_dwordx4 v[180:183], v12, s[28:31], s45 offen offset:1024 sc1
    v_mfma_f32_16x16x32_bf16 v[36:39], v[96:99], v[140:143], v[36:39]
    ds_read_b64_tr_b16 v[90:91], v7 offset:39456
    v_mfma_f32_16x16x32_bf16 v[40:43], v[100:103], v[136:139], v[40:43]
    ds_read_b64_tr_b16 v[92:93], v7 offset:35904
    v_mfma_f32_16x16x32_bf16 v[44:47], v[100:103], v[140:143], v[44:47]
    ds_read_b64_tr_b16 v[94:95], v7 offset:39488
    s_waitcnt lgkmcnt(8)
    v_mfma_f32_16x16x32_bf16 v[48:51], v[72:75], v[136:139], v[48:51]
    ds_read_b64_tr_b16 v[96:97], v7 offset:35936
    v_mfma_f32_16x16x32_bf16 v[52:55], v[72:75], v[140:143], v[52:55]
    ds_read_b64_tr_b16 v[98:99], v7 offset:39520
    v_mfma_f32_16x16x32_bf16 v[56:59], v[76:79], v[136:139], v[56:59]
    ds_read_b64_tr_b16 v[100:101], v7 offset:35968
    v_mfma_f32_16x16x32_bf16 v[60:63], v[76:79], v[140:143], v[60:63]
    ds_read_b64_tr_b16 v[102:103], v7 offset:39552
    s_waitcnt lgkmcnt(8)
    v_mfma_f32_16x16x32_bf16 v[64:67], v[80:83], v[136:139], v[64:67]
    ds_read_b64_tr_b16 v[72:73], v7 offset:36000
    s_waitcnt vmcnt(18)
    v_mfma_f32_16x16x32_bf16 v[68:71], v[80:83], v[140:143], v[68:71]
    ds_read_b64_tr_b16 v[74:75], v7 offset:39584
    v_mfma_f32_16x16x32_bf16 v[16:19], v[84:87], v[144:147], v[16:19]
    ds_read_b64_tr_b16 v[76:77], v7 offset:36032
    buffer_load_dwordx4 v[104:107], v12, s[28:31], s44 offen offset:2048 sc1
    v_mfma_f32_16x16x32_bf16 v[20:23], v[84:87], v[148:151], v[20:23]
    ds_read_b64_tr_b16 v[78:79], v7 offset:39616
    s_waitcnt lgkmcnt(8)
    v_mfma_f32_16x16x32_bf16 v[24:27], v[88:91], v[144:147], v[24:27]
    ds_read_b64_tr_b16 v[80:81], v7 offset:43008
    v_mfma_f32_16x16x32_bf16 v[28:31], v[88:91], v[148:151], v[28:31]
    ds_read_b64_tr_b16 v[82:83], v7 offset:46592
    v_mfma_f32_16x16x32_bf16 v[32:35], v[92:95], v[144:147], v[32:35]
    ds_read_b64_tr_b16 v[84:85], v7 offset:43040
    buffer_load_dwordx4 v[108:111], v12, s[28:31], s45 offen offset:2048 sc1
    v_mfma_f32_16x16x32_bf16 v[36:39], v[92:95], v[148:151], v[36:39]
    ds_read_b64_tr_b16 v[86:87], v7 offset:46624
    s_waitcnt lgkmcnt(8)
    v_mfma_f32_16x16x32_bf16 v[40:43], v[96:99], v[144:147], v[40:43]
    ds_read_b64_tr_b16 v[88:89], v7 offset:43072
    v_mfma_f32_16x16x32_bf16 v[44:47], v[96:99], v[148:151], v[44:47]
    ds_read_b64_tr_b16 v[90:91], v7 offset:46656
    v_mfma_f32_16x16x32_bf16 v[48:51], v[100:103], v[144:147], v[48:51]
    ds_read_b64_tr_b16 v[92:93], v7 offset:43104
    v_mfma_f32_16x16x32_bf16 v[52:55], v[100:103], v[148:151], v[52:55]
    ds_read_b64_tr_b16 v[94:95], v7 offset:46688
    s_waitcnt lgkmcnt(8)
    v_mfma_f32_16x16x32_bf16 v[56:59], v[72:75], v[144:147], v[56:59]
    ds_read_b64_tr_b16 v[96:97], v7 offset:43136
    v_mfma_f32_16x16x32_bf16 v[60:63], v[72:75], v[148:151], v[60:63]
    ds_read_b64_tr_b16 v[98:99], v7 offset:46720
    v_mfma_f32_16x16x32_bf16 v[64:67], v[76:79], v[144:147], v[64:67]
    ds_read_b64_tr_b16 v[100:101], v7 offset:43168
    s_waitcnt vmcnt(15)
    v_mfma_f32_16x16x32_bf16 v[68:71], v[76:79], v[148:151], v[68:71]
    ds_read_b64_tr_b16 v[102:103], v7 offset:46752
    s_waitcnt lgkmcnt(8)
    v_mfma_f32_16x16x32_bf16 v[16:19], v[80:83], v[152:155], v[16:19]
    ds_read_b64_tr_b16 v[72:73], v7 offset:43200
    buffer_load_dwordx4 v[112:115], v12, s[28:31], s44 offen offset:3072 sc1
    v_mfma_f32_16x16x32_bf16 v[20:23], v[80:83], v[156:159], v[20:23]
    ds_read_b64_tr_b16 v[74:75], v7 offset:46784
    v_mfma_f32_16x16x32_bf16 v[24:27], v[84:87], v[152:155], v[24:27]
    ds_read_b64_tr_b16 v[76:77], v7 offset:50176
    v_mfma_f32_16x16x32_bf16 v[28:31], v[84:87], v[156:159], v[28:31]
    ds_read_b64_tr_b16 v[78:79], v7 offset:53760
    s_waitcnt lgkmcnt(8)
    v_mfma_f32_16x16x32_bf16 v[32:35], v[88:91], v[152:155], v[32:35]
    ds_read_b64_tr_b16 v[80:81], v7 offset:50208
    buffer_load_dwordx4 v[116:119], v12, s[28:31], s45 offen offset:3072 sc1
    v_mfma_f32_16x16x32_bf16 v[36:39], v[88:91], v[156:159], v[36:39]
    ds_read_b64_tr_b16 v[82:83], v7 offset:53792
    v_mfma_f32_16x16x32_bf16 v[40:43], v[92:95], v[152:155], v[40:43]
    ds_read_b64_tr_b16 v[84:85], v7 offset:50240
    v_mfma_f32_16x16x32_bf16 v[44:47], v[92:95], v[156:159], v[44:47]
    ds_read_b64_tr_b16 v[86:87], v7 offset:53824
    s_waitcnt lgkmcnt(8)
    v_mfma_f32_16x16x32_bf16 v[48:51], v[96:99], v[152:155], v[48:51]
    ds_read_b64_tr_b16 v[88:89], v7 offset:50272
    buffer_load_dwordx4 a[88:91], v12, s[28:31], s21 offen offset:2048 sc1
    v_mfma_f32_16x16x32_bf16 v[52:55], v[96:99], v[156:159], v[52:55]
    ds_read_b64_tr_b16 v[90:91], v7 offset:53856
    v_mfma_f32_16x16x32_bf16 v[56:59], v[100:103], v[152:155], v[56:59]
    ds_read_b64_tr_b16 v[92:93], v7 offset:50304
    v_mfma_f32_16x16x32_bf16 v[60:63], v[100:103], v[156:159], v[60:63]
    ds_read_b64_tr_b16 v[94:95], v7 offset:53888
    s_waitcnt lgkmcnt(8)
    v_mfma_f32_16x16x32_bf16 v[64:67], v[72:75], v[152:155], v[64:67]
    ds_read_b64_tr_b16 v[96:97], v7 offset:50336
    s_waitcnt vmcnt(9)
    v_mfma_f32_16x16x32_bf16 v[68:71], v[72:75], v[156:159], v[68:71]
    ds_read_b64_tr_b16 v[98:99], v7 offset:53920
    v_mfma_f32_16x16x32_bf16 v[16:19], v[76:79], v[160:163], v[16:19]
    ds_read_b64_tr_b16 v[100:101], v7 offset:50368
    s_add_u32 s44, s44, 4096
    buffer_load_dwordx4 v[120:123], v12, s[28:31], s44 offen offset:0 sc1
    v_mfma_f32_16x16x32_bf16 v[20:23], v[76:79], v[164:167], v[20:23]
    ds_read_b64_tr_b16 v[102:103], v7 offset:53952
    s_waitcnt lgkmcnt(8)
    v_mfma_f32_16x16x32_bf16 v[24:27], v[80:83], v[160:163], v[24:27]
    ds_read_b64_tr_b16 v[72:73], v7 offset:57344
    v_mfma_f32_16x16x32_bf16 v[28:31], v[80:83], v[164:167], v[28:31]
    ds_read_b64_tr_b16 v[74:75], v7 offset:60928
    v_mfma_f32_16x16x32_bf16 v[32:35], v[84:87], v[160:163], v[32:35]
    ds_read_b64_tr_b16 v[76:77], v7 offset:57376
    s_add_u32 s45, s45, 4096
    buffer_load_dwordx4 v[124:127], v12, s[28:31], s45 offen offset:0 sc1
    v_mfma_f32_16x16x32_bf16 v[36:39], v[84:87], v[164:167], v[36:39]
    ds_read_b64_tr_b16 v[78:79], v7 offset:60960
    s_waitcnt lgkmcnt(8)
    v_mfma_f32_16x16x32_bf16 v[40:43], v[88:91], v[160:163], v[40:43]
    ds_read_b64_tr_b16 v[80:81], v7 offset:57408
    v_mfma_f32_16x16x32_bf16 v[44:47], v[88:91], v[164:167], v[44:47]
    ds_read_b64_tr_b16 v[82:83], v7 offset:60992
    v_mfma_f32_16x16x32_bf16 v[48:51], v[92:95], v[160:163], v[48:51]
    ds_read_b64_tr_b16 v[84:85], v7 offset:57440
    buffer_load_dwordx4 a[92:95], v12, s[28:31], s21 offen offset:3072 sc1
    v_mfma_f32_16x16x32_bf16 v[52:55], v[92:95], v[164:167], v[52:55]
    ds_read_b64_tr_b16 v[86:87], v7 offset:61024
    s_waitcnt lgkmcnt(8)
    v_mfma_f32_16x16x32_bf16 v[56:59], v[96:99], v[160:163], v[56:59]
    ds_read_b64_tr_b16 v[88:89], v7 offset:57472
    s_add_u32 s21, s21, 4096
    buffer_load_dwordx4 a[96:99], v12, s[28:31], s21 offen offset:0 sc1
    v_mfma_f32_16x16x32_bf16 v[60:63], v[96:99], v[164:167], v[60:63]
    ds_read_b64_tr_b16 v[90:91], v7 offset:61056
    v_mfma_f32_16x16x32_bf16 v[64:67], v[100:103], v[160:163], v[64:67]
    ds_read_b64_tr_b16 v[92:93], v7 offset:57504
    s_waitcnt vmcnt(11)
    v_mfma_f32_16x16x32_bf16 v[68:71], v[100:103], v[164:167], v[68:71]
    ds_read_b64_tr_b16 v[94:95], v7 offset:61088
    s_waitcnt lgkmcnt(8)
    v_mfma_f32_16x16x32_bf16 v[16:19], v[72:75], v[168:171], v[16:19]
    ds_read_b64_tr_b16 v[96:97], v7 offset:57536
    buffer_load_dwordx4 v[128:131], v12, s[28:31], s44 offen offset:1024 sc1
    v_mfma_f32_16x16x32_bf16 v[20:23], v[72:75], v[172:175], v[20:23]
    ds_read_b64_tr_b16 v[98:99], v7 offset:61120
    s_waitcnt vmcnt(15)
    v_mfma_f32_16x16x32_bf16 v[24:27], v[76:79], v[168:171], v[24:27]
    ds_read_b64_tr_b16 v[100:101], v8 offset:0
    v_add_f32 v212, v212, v213
    v_mfma_f32_16x16x32_bf16 v[28:31], v[76:79], v[172:175], v[28:31]
    ds_read_b64_tr_b16 v[102:103], v8 offset:3584
    s_waitcnt lgkmcnt(8)
    v_mfma_f32_16x16x32_bf16 v[32:35], v[80:83], v[168:171], v[32:35]
    ds_read_b64_tr_b16 v[72:73], v8 offset:32
    buffer_load_dwordx4 v[132:135], v12, s[28:31], s45 offen offset:1024 sc1
    v_mfma_f32_16x16x32_bf16 v[36:39], v[80:83], v[172:175], v[36:39]
    ds_read_b64_tr_b16 v[74:75], v8 offset:3616
    v_add_f32 v214, v214, v215
    v_mfma_f32_16x16x32_bf16 v[40:43], v[84:87], v[168:171], v[40:43]
    ds_read_b64_tr_b16 v[76:77], v8 offset:64
    v_add_f32 v212, v212, v216
    v_mfma_f32_16x16x32_bf16 v[44:47], v[84:87], v[172:175], v[44:47]
    ds_read_b64_tr_b16 v[78:79], v8 offset:3648
    s_waitcnt lgkmcnt(8)
    v_mfma_f32_16x16x32_bf16 v[48:51], v[88:91], v[168:171], v[48:51]
    ds_read_b64_tr_b16 v[80:81], v8 offset:96
    buffer_load_dwordx4 a[100:103], v12, s[28:31], s21 offen offset:1024 sc1
    v_mfma_f32_16x16x32_bf16 v[52:55], v[88:91], v[172:175], v[52:55]
    ds_read_b64_tr_b16 v[82:83], v8 offset:3680
    v_add_f32 v222, v212, v214
    v_mfma_f32_16x16x32_bf16 v[56:59], v[92:95], v[168:171], v[56:59]
    ds_read_b64_tr_b16 v[84:85], v8 offset:128
    v_add_f32 v217, v217, v218
    v_mfma_f32_16x16x32_bf16 v[60:63], v[92:95], v[172:175], v[60:63]
    ds_read_b64_tr_b16 v[86:87], v8 offset:3712
    s_waitcnt lgkmcnt(8)
    v_mfma_f32_16x16x32_bf16 v[64:67], v[96:99], v[168:171], v[64:67]
    ds_read_b64_tr_b16 v[88:89], v8 offset:160
    s_waitcnt vmcnt(12)
    v_mfma_f32_16x16x32_bf16 v[68:71], v[96:99], v[172:175], v[68:71]
    ds_read_b64_tr_b16 v[90:91], v8 offset:3744
    v_add_f32 v219, v219, v220
    v_mfma_f32_16x16x32_bf16 v[16:19], v[100:103], v[176:179], v[16:19]
    ds_read_b64_tr_b16 v[92:93], v8 offset:192
    buffer_load_dwordx4 v[136:139], v12, s[28:31], s44 offen offset:2048 sc1
    v_mfma_f32_16x16x32_bf16 v[20:23], v[100:103], v[180:183], v[20:23]
    ds_read_b64_tr_b16 v[94:95], v8 offset:3776
    s_waitcnt lgkmcnt(8)
    v_mfma_f32_16x16x32_bf16 v[24:27], v[72:75], v[176:179], v[24:27]
    ds_read_b64_tr_b16 v[96:97], v8 offset:7168
    v_add_f32 v217, v217, v221
    v_mfma_f32_16x16x32_bf16 v[28:31], v[72:75], v[180:183], v[28:31]
    ds_read_b64_tr_b16 v[98:99], v8 offset:10752
    v_add_f32 v223, v217, v219
    v_mfma_f32_16x16x32_bf16 v[32:35], v[76:79], v[176:179], v[32:35]
    ds_read_b64_tr_b16 v[100:101], v8 offset:7200
    buffer_load_dwordx4 v[140:143], v12, s[28:31], s45 offen offset:2048 sc1
    v_mfma_f32_16x16x32_bf16 v[36:39], v[76:79], v[180:183], v[36:39]
    ds_read_b64_tr_b16 v[102:103], v8 offset:10784
    s_waitcnt lgkmcnt(8)
    v_mfma_f32_16x16x32_bf16 v[40:43], v[80:83], v[176:179], v[40:43]
    ds_read_b64_tr_b16 v[72:73], v8 offset:7232
    v_mov_b32 v224, v222
    v_mfma_f32_16x16x32_bf16 v[44:47], v[80:83], v[180:183], v[44:47]
    ds_read_b64_tr_b16 v[74:75], v8 offset:10816
    v_mov_b32 v225, v223
    v_mfma_f32_16x16x32_bf16 v[48:51], v[84:87], v[176:179], v[48:51]
    ds_read_b64_tr_b16 v[76:77], v8 offset:7264
    buffer_load_dwordx4 a[104:107], v12, s[28:31], s21 offen offset:2048 sc1
    v_mfma_f32_16x16x32_bf16 v[52:55], v[84:87], v[180:183], v[52:55]
    ds_read_b64_tr_b16 v[78:79], v8 offset:10848
    s_waitcnt lgkmcnt(8)
    v_mfma_f32_16x16x32_bf16 v[56:59], v[88:91], v[176:179], v[56:59]
    ds_read_b64_tr_b16 v[80:81], v8 offset:7296
    buffer_load_dwordx4 a[108:111], v12, s[28:31], s21 offen offset:3072 sc1
    v_mfma_f32_16x16x32_bf16 v[60:63], v[88:91], v[180:183], v[60:63]
    ds_read_b64_tr_b16 v[82:83], v8 offset:10880
    v_permlane32_swap_b32 v222, v224
    v_mfma_f32_16x16x32_bf16 v[64:67], v[92:95], v[176:179], v[64:67]
    ds_read_b64_tr_b16 v[84:85], v8 offset:7328
    s_waitcnt vmcnt(14)
    v_mfma_f32_16x16x32_bf16 v[68:71], v[92:95], v[180:183], v[68:71]
    ds_read_b64_tr_b16 v[86:87], v8 offset:10912
    s_waitcnt lgkmcnt(8)
    v_mfma_f32_16x16x32_bf16 v[16:19], v[96:99], v[104:107], v[16:19]
    ds_read_b64_tr_b16 v[88:89], v8 offset:7360
    buffer_load_dwordx4 v[144:147], v12, s[28:31], s44 offen offset:3072 sc1
    v_mfma_f32_16x16x32_bf16 v[20:23], v[96:99], v[108:111], v[20:23]
    ds_read_b64_tr_b16 v[90:91], v8 offset:10944
    v_permlane32_swap_b32 v223, v225
    v_mfma_f32_16x16x32_bf16 v[24:27], v[100:103], v[104:107], v[24:27]
    ds_read_b64_tr_b16 v[92:93], v8 offset:14336
    v_add_f32 v222, v222, v224
    v_mfma_f32_16x16x32_bf16 v[28:31], v[100:103], v[108:111], v[28:31]
    ds_read_b64_tr_b16 v[94:95], v8 offset:17920
    s_waitcnt lgkmcnt(8)
    v_mfma_f32_16x16x32_bf16 v[32:35], v[72:75], v[104:107], v[32:35]
    ds_read_b64_tr_b16 v[96:97], v8 offset:14368
    buffer_load_dwordx4 v[148:151], v12, s[28:31], s45 offen offset:3072 sc1
    v_mfma_f32_16x16x32_bf16 v[36:39], v[72:75], v[108:111], v[36:39]
    ds_read_b64_tr_b16 v[98:99], v8 offset:17952
    v_add_f32 v223, v223, v225
    v_mfma_f32_16x16x32_bf16 v[40:43], v[76:79], v[104:107], v[40:43]
    ds_read_b64_tr_b16 v[100:101], v8 offset:14400
    v_mov_b32 v224, v222
    v_mfma_f32_16x16x32_bf16 v[44:47], v[76:79], v[108:111], v[44:47]
    ds_read_b64_tr_b16 v[102:103], v8 offset:17984
    s_waitcnt lgkmcnt(8)
    v_mfma_f32_16x16x32_bf16 v[48:51], v[80:83], v[104:107], v[48:51]
    ds_read_b64_tr_b16 v[72:73], v8 offset:14432
    s_add_u32 s21, s21, 4096
    buffer_load_dwordx4 a[112:115], v12, s[28:31], s21 offen offset:0 sc1
    v_mfma_f32_16x16x32_bf16 v[52:55], v[80:83], v[108:111], v[52:55]
    ds_read_b64_tr_b16 v[74:75], v8 offset:18016
    v_mov_b32 v225, v223
    v_mfma_f32_16x16x32_bf16 v[56:59], v[84:87], v[104:107], v[56:59]
    ds_read_b64_tr_b16 v[76:77], v8 offset:14464
    v_permlane16_swap_b32 v222, v224
    v_mfma_f32_16x16x32_bf16 v[60:63], v[84:87], v[108:111], v[60:63]
    ds_read_b64_tr_b16 v[78:79], v8 offset:18048
    s_waitcnt lgkmcnt(8)
    v_mfma_f32_16x16x32_bf16 v[64:67], v[88:91], v[104:107], v[64:67]
    ds_read_b64_tr_b16 v[80:81], v8 offset:14496
    s_waitcnt vmcnt(15)
    v_mfma_f32_16x16x32_bf16 v[68:71], v[88:91], v[108:111], v[68:71]
    ds_read_b64_tr_b16 v[82:83], v8 offset:18080
    v_permlane16_swap_b32 v223, v225
    v_mfma_f32_16x16x32_bf16 v[16:19], v[92:95], v[112:115], v[16:19]
    ds_read_b64_tr_b16 v[84:85], v8 offset:14528
    s_add_u32 s44, s44, 4096
    buffer_load_dwordx4 v[152:155], v12, s[28:31], s44 offen offset:0 sc1
    v_mfma_f32_16x16x32_bf16 v[20:23], v[92:95], v[116:119], v[20:23]
    ds_read_b64_tr_b16 v[86:87], v8 offset:18112
    s_waitcnt lgkmcnt(8)
    v_mfma_f32_16x16x32_bf16 v[24:27], v[96:99], v[112:115], v[24:27]
    ds_read_b64_tr_b16 v[88:89], v8 offset:21504
    v_add_f32 v222, v222, v224
    v_mfma_f32_16x16x32_bf16 v[28:31], v[96:99], v[116:119], v[28:31]
    ds_read_b64_tr_b16 v[90:91], v8 offset:25088
    v_add_f32 v223, v223, v225
    v_mfma_f32_16x16x32_bf16 v[32:35], v[100:103], v[112:115], v[32:35]
    ds_read_b64_tr_b16 v[92:93], v8 offset:21536
    s_add_u32 s45, s45, 4096
    buffer_load_dwordx4 v[156:159], v12, s[28:31], s45 offen offset:0 sc1
    v_mfma_f32_16x16x32_bf16 v[36:39], v[100:103], v[116:119], v[36:39]
    ds_read_b64_tr_b16 v[94:95], v8 offset:25120
    s_waitcnt lgkmcnt(8)
    v_mfma_f32_16x16x32_bf16 v[40:43], v[72:75], v[112:115], v[40:43]
    ds_read_b64_tr_b16 v[96:97], v8 offset:21568
    v_mul_f32 v10, 0x3acccccd, v222
    v_mfma_f32_16x16x32_bf16 v[44:47], v[72:75], v[116:119], v[44:47]
    ds_read_b64_tr_b16 v[98:99], v8 offset:25152
    v_mul_f32 v2, 0x3acccccd, v223
    v_mfma_f32_16x16x32_bf16 v[48:51], v[76:79], v[112:115], v[48:51]
    ds_read_b64_tr_b16 v[100:101], v8 offset:21600
    buffer_load_dwordx4 a[116:119], v12, s[28:31], s21 offen offset:1024 sc1
    v_mfma_f32_16x16x32_bf16 v[52:55], v[76:79], v[116:119], v[52:55]
    ds_read_b64_tr_b16 v[102:103], v8 offset:25184
    s_waitcnt lgkmcnt(8)
    v_mfma_f32_16x16x32_bf16 v[56:59], v[80:83], v[112:115], v[56:59]
    ds_read_b64_tr_b16 v[72:73], v8 offset:21632
    buffer_load_dwordx4 a[120:123], v12, s[28:31], s21 offen offset:2048 sc1
    v_mfma_f32_16x16x32_bf16 v[60:63], v[80:83], v[116:119], v[60:63]
    ds_read_b64_tr_b16 v[74:75], v8 offset:25216
    v_mfma_f32_16x16x32_bf16 v[64:67], v[84:87], v[112:115], v[64:67]
    ds_read_b64_tr_b16 v[76:77], v8 offset:21664
    s_waitcnt vmcnt(16)
    v_mfma_f32_16x16x32_bf16 v[68:71], v[84:87], v[116:119], v[68:71]
    ds_read_b64_tr_b16 v[78:79], v8 offset:25248
    s_waitcnt lgkmcnt(8)
    v_mfma_f32_16x16x32_bf16 v[16:19], v[88:91], v[120:123], v[16:19]
    ds_read_b64_tr_b16 v[80:81], v8 offset:21696
    buffer_load_dwordx4 v[160:163], v12, s[28:31], s44 offen offset:1024 sc1
    v_mfma_f32_16x16x32_bf16 v[20:23], v[88:91], v[124:127], v[20:23]
    ds_read_b64_tr_b16 v[82:83], v8 offset:25280
    v_mfma_f32_16x16x32_bf16 v[24:27], v[92:95], v[120:123], v[24:27]
    ds_read_b64_tr_b16 v[84:85], v8 offset:28672
    v_mfma_f32_16x16x32_bf16 v[28:31], v[92:95], v[124:127], v[28:31]
    ds_read_b64_tr_b16 v[86:87], v8 offset:32256
    s_waitcnt lgkmcnt(8)
    v_mfma_f32_16x16x32_bf16 v[32:35], v[96:99], v[120:123], v[32:35]
    ds_read_b64_tr_b16 v[88:89], v8 offset:28704
    buffer_load_dwordx4 v[164:167], v12, s[28:31], s45 offen offset:1024 sc1
    v_mfma_f32_16x16x32_bf16 v[36:39], v[96:99], v[124:127], v[36:39]
    ds_read_b64_tr_b16 v[90:91], v8 offset:32288
    v_mfma_f32_16x16x32_bf16 v[40:43], v[100:103], v[120:123], v[40:43]
    ds_read_b64_tr_b16 v[92:93], v8 offset:28736
    v_mfma_f32_16x16x32_bf16 v[44:47], v[100:103], v[124:127], v[44:47]
    ds_read_b64_tr_b16 v[94:95], v8 offset:32320
    s_waitcnt lgkmcnt(8)
    v_mfma_f32_16x16x32_bf16 v[48:51], v[72:75], v[120:123], v[48:51]
    ds_read_b64_tr_b16 v[96:97], v8 offset:28768
    buffer_load_dwordx4 a[124:127], v12, s[28:31], s21 offen offset:3072 sc1
    v_mfma_f32_16x16x32_bf16 v[52:55], v[72:75], v[124:127], v[52:55]
    ds_read_b64_tr_b16 v[98:99], v8 offset:32352
    v_mfma_f32_16x16x32_bf16 v[56:59], v[76:79], v[120:123], v[56:59]
    ds_read_b64_tr_b16 v[100:101], v8 offset:28800
    v_mfma_f32_16x16x32_bf16 v[60:63], v[76:79], v[124:127], v[60:63]
    ds_read_b64_tr_b16 v[102:103], v8 offset:32384
    s_waitcnt lgkmcnt(8)
    v_mfma_f32_16x16x32_bf16 v[64:67], v[80:83], v[120:123], v[64:67]
    ds_read_b64_tr_b16 v[72:73], v8 offset:28832
    s_waitcnt vmcnt(15)
    v_mfma_f32_16x16x32_bf16 v[68:71], v[80:83], v[124:127], v[68:71]
    ds_read_b64_tr_b16 v[74:75], v8 offset:32416
    v_mfma_f32_16x16x32_bf16 v[16:19], v[84:87], v[128:131], v[16:19]
    ds_read_b64_tr_b16 v[76:77], v8 offset:28864
    buffer_load_dwordx4 v[168:171], v12, s[28:31], s44 offen offset:2048 sc1
    v_mfma_f32_16x16x32_bf16 v[20:23], v[84:87], v[132:135], v[20:23]
    ds_read_b64_tr_b16 v[78:79], v8 offset:32448
    s_waitcnt lgkmcnt(8)
    v_mfma_f32_16x16x32_bf16 v[24:27], v[88:91], v[128:131], v[24:27]
    ds_read_b64_tr_b16 v[80:81], v8 offset:35840
    v_mfma_f32_16x16x32_bf16 v[28:31], v[88:91], v[132:135], v[28:31]
    ds_read_b64_tr_b16 v[82:83], v8 offset:39424
    v_mfma_f32_16x16x32_bf16 v[32:35], v[92:95], v[128:131], v[32:35]
    ds_read_b64_tr_b16 v[84:85], v8 offset:35872
    buffer_load_dwordx4 v[172:175], v12, s[28:31], s45 offen offset:2048 sc1
    v_mfma_f32_16x16x32_bf16 v[36:39], v[92:95], v[132:135], v[36:39]
    ds_read_b64_tr_b16 v[86:87], v8 offset:39456
    s_waitcnt lgkmcnt(8)
    v_mfma_f32_16x16x32_bf16 v[40:43], v[96:99], v[128:131], v[40:43]
    ds_read_b64_tr_b16 v[88:89], v8 offset:35904
    v_mfma_f32_16x16x32_bf16 v[44:47], v[96:99], v[132:135], v[44:47]
    ds_read_b64_tr_b16 v[90:91], v8 offset:39488
    v_mfma_f32_16x16x32_bf16 v[48:51], v[100:103], v[128:131], v[48:51]
    ds_read_b64_tr_b16 v[92:93], v8 offset:35936
    s_add_u32 s21, s21, 4096
    buffer_load_dwordx4 a[128:131], v12, s[28:31], s21 offen offset:0 sc1
    v_mfma_f32_16x16x32_bf16 v[52:55], v[100:103], v[132:135], v[52:55]
    ds_read_b64_tr_b16 v[94:95], v8 offset:39520
    s_waitcnt lgkmcnt(8)
    v_mfma_f32_16x16x32_bf16 v[56:59], v[72:75], v[128:131], v[56:59]
    ds_read_b64_tr_b16 v[96:97], v8 offset:35968
    buffer_load_dwordx4 a[132:135], v12, s[28:31], s21 offen offset:1024 sc1
    v_mfma_f32_16x16x32_bf16 v[60:63], v[72:75], v[132:135], v[60:63]
    ds_read_b64_tr_b16 v[98:99], v8 offset:39552
    v_mfma_f32_16x16x32_bf16 v[64:67], v[76:79], v[128:131], v[64:67]
    ds_read_b64_tr_b16 v[100:101], v8 offset:36000
    s_waitcnt vmcnt(16)
    v_mfma_f32_16x16x32_bf16 v[68:71], v[76:79], v[132:135], v[68:71]
    ds_read_b64_tr_b16 v[102:103], v8 offset:39584
    s_waitcnt lgkmcnt(8)
    v_mfma_f32_16x16x32_bf16 v[16:19], v[80:83], v[136:139], v[16:19]
    ds_read_b64_tr_b16 v[72:73], v8 offset:36032
    buffer_load_dwordx4 v[176:179], v12, s[28:31], s44 offen offset:3072 sc1
    v_mfma_f32_16x16x32_bf16 v[20:23], v[80:83], v[140:143], v[20:23]
    ds_read_b64_tr_b16 v[74:75], v8 offset:39616
    v_mfma_f32_16x16x32_bf16 v[24:27], v[84:87], v[136:139], v[24:27]
    ds_read_b64_tr_b16 v[76:77], v8 offset:43008
    v_mfma_f32_16x16x32_bf16 v[28:31], v[84:87], v[140:143], v[28:31]
    ds_read_b64_tr_b16 v[78:79], v8 offset:46592
    s_waitcnt lgkmcnt(8)
    v_mfma_f32_16x16x32_bf16 v[32:35], v[88:91], v[136:139], v[32:35]
    ds_read_b64_tr_b16 v[80:81], v8 offset:43040
    buffer_load_dwordx4 v[180:183], v12, s[28:31], s45 offen offset:3072 sc1
    v_mfma_f32_16x16x32_bf16 v[36:39], v[88:91], v[140:143], v[36:39]
    ds_read_b64_tr_b16 v[82:83], v8 offset:46624
    v_mfma_f32_16x16x32_bf16 v[40:43], v[92:95], v[136:139], v[40:43]
    ds_read_b64_tr_b16 v[84:85], v8 offset:43072
    v_mfma_f32_16x16x32_bf16 v[44:47], v[92:95], v[140:143], v[44:47]
    ds_read_b64_tr_b16 v[86:87], v8 offset:46656
    s_waitcnt lgkmcnt(8)
    v_mfma_f32_16x16x32_bf16 v[48:51], v[96:99], v[136:139], v[48:51]
    ds_read_b64_tr_b16 v[88:89], v8 offset:43104
    buffer_load_dwordx4 a[136:139], v12, s[28:31], s21 offen offset:2048 sc1
    v_mfma_f32_16x16x32_bf16 v[52:55], v[96:99], v[140:143], v[52:55]
    ds_read_b64_tr_b16 v[90:91], v8 offset:46688
    v_mfma_f32_16x16x32_bf16 v[56:59], v[100:103], v[136:139], v[56:59]
    ds_read_b64_tr_b16 v[92:93], v8 offset:43136
    v_mfma_f32_16x16x32_bf16 v[60:63], v[100:103], v[140:143], v[60:63]
    ds_read_b64_tr_b16 v[94:95], v8 offset:46720
    s_waitcnt lgkmcnt(8)
    v_mfma_f32_16x16x32_bf16 v[64:67], v[72:75], v[136:139], v[64:67]
    ds_read_b64_tr_b16 v[96:97], v8 offset:43168
    s_waitcnt vmcnt(15)
    v_mfma_f32_16x16x32_bf16 v[68:71], v[72:75], v[140:143], v[68:71]
    ds_read_b64_tr_b16 v[98:99], v8 offset:46752
    v_mfma_f32_16x16x32_bf16 v[16:19], v[76:79], v[144:147], v[16:19]
    ds_read_b64_tr_b16 v[100:101], v8 offset:43200
    buffer_load_dwordx4 a[140:143], v12, s[28:31], s21 offen offset:3072 sc1
    v_mfma_f32_16x16x32_bf16 v[20:23], v[76:79], v[148:151], v[20:23]
    ds_read_b64_tr_b16 v[102:103], v8 offset:46784
    s_waitcnt lgkmcnt(8)
    v_mfma_f32_16x16x32_bf16 v[24:27], v[80:83], v[144:147], v[24:27]
    ds_read_b64_tr_b16 v[72:73], v8 offset:50176
    v_mfma_f32_16x16x32_bf16 v[28:31], v[80:83], v[148:151], v[28:31]
    ds_read_b64_tr_b16 v[74:75], v8 offset:53760
    v_mfma_f32_16x16x32_bf16 v[32:35], v[84:87], v[144:147], v[32:35]
    ds_read_b64_tr_b16 v[76:77], v8 offset:50208
    s_add_u32 s21, s21, 4096
    buffer_load_dwordx4 a[144:147], v12, s[28:31], s21 offen offset:0 sc1
    v_mfma_f32_16x16x32_bf16 v[36:39], v[84:87], v[148:151], v[36:39]
    ds_read_b64_tr_b16 v[78:79], v8 offset:53792
    s_waitcnt lgkmcnt(8)
    v_mfma_f32_16x16x32_bf16 v[40:43], v[88:91], v[144:147], v[40:43]
    ds_read_b64_tr_b16 v[80:81], v8 offset:50240
    v_mfma_f32_16x16x32_bf16 v[44:47], v[88:91], v[148:151], v[44:47]
    ds_read_b64_tr_b16 v[82:83], v8 offset:53824
    v_mfma_f32_16x16x32_bf16 v[48:51], v[92:95], v[144:147], v[48:51]
    ds_read_b64_tr_b16 v[84:85], v8 offset:50272
    buffer_load_dwordx4 a[148:151], v12, s[28:31], s21 offen offset:1024 sc1
    v_mfma_f32_16x16x32_bf16 v[52:55], v[92:95], v[148:151], v[52:55]
    ds_read_b64_tr_b16 v[86:87], v8 offset:53856
    s_waitcnt lgkmcnt(8)
    v_mfma_f32_16x16x32_bf16 v[56:59], v[96:99], v[144:147], v[56:59]
    ds_read_b64_tr_b16 v[88:89], v8 offset:50304
    buffer_load_dwordx4 a[152:155], v12, s[28:31], s21 offen offset:2048 sc1
    v_mfma_f32_16x16x32_bf16 v[60:63], v[96:99], v[148:151], v[60:63]
    ds_read_b64_tr_b16 v[90:91], v8 offset:53888
    v_mfma_f32_16x16x32_bf16 v[64:67], v[100:103], v[144:147], v[64:67]
    ds_read_b64_tr_b16 v[92:93], v8 offset:50336
    s_waitcnt vmcnt(16)
    v_mfma_f32_16x16x32_bf16 v[68:71], v[100:103], v[148:151], v[68:71]
    ds_read_b64_tr_b16 v[94:95], v8 offset:53920
    s_waitcnt lgkmcnt(8)
    v_mfma_f32_16x16x32_bf16 v[16:19], v[72:75], v[152:155], v[16:19]
    ds_read_b64_tr_b16 v[96:97], v8 offset:50368
    buffer_load_dwordx4 a[156:159], v12, s[28:31], s21 offen offset:3072 sc1
    v_mfma_f32_16x16x32_bf16 v[20:23], v[72:75], v[156:159], v[20:23]
    ds_read_b64_tr_b16 v[98:99], v8 offset:53952
    v_mfma_f32_16x16x32_bf16 v[24:27], v[76:79], v[152:155], v[24:27]
    ds_read_b64_tr_b16 v[100:101], v8 offset:57344
    v_mfma_f32_16x16x32_bf16 v[28:31], v[76:79], v[156:159], v[28:31]
    ds_read_b64_tr_b16 v[102:103], v8 offset:60928
    s_waitcnt lgkmcnt(8)
    v_mfma_f32_16x16x32_bf16 v[32:35], v[80:83], v[152:155], v[32:35]
    ds_read_b64_tr_b16 v[72:73], v8 offset:57376
    s_add_u32 s21, s21, 4096
    buffer_load_dwordx4 a[160:163], v12, s[28:31], s21 offen offset:0 sc1
    v_mfma_f32_16x16x32_bf16 v[36:39], v[80:83], v[156:159], v[36:39]
    ds_read_b64_tr_b16 v[74:75], v8 offset:60960
    v_mfma_f32_16x16x32_bf16 v[40:43], v[84:87], v[152:155], v[40:43]
    ds_read_b64_tr_b16 v[76:77], v8 offset:57408
    v_mfma_f32_16x16x32_bf16 v[44:47], v[84:87], v[156:159], v[44:47]
    ds_read_b64_tr_b16 v[78:79], v8 offset:60992
    s_waitcnt lgkmcnt(8)
    v_mfma_f32_16x16x32_bf16 v[48:51], v[88:91], v[152:155], v[48:51]
    ds_read_b64_tr_b16 v[80:81], v8 offset:57440
    buffer_load_dwordx4 a[164:167], v12, s[28:31], s21 offen offset:1024 sc1
    v_mfma_f32_16x16x32_bf16 v[52:55], v[88:91], v[156:159], v[52:55]
    ds_read_b64_tr_b16 v[82:83], v8 offset:61024
    v_mfma_f32_16x16x32_bf16 v[56:59], v[92:95], v[152:155], v[56:59]
    ds_read_b64_tr_b16 v[84:85], v8 offset:57472
    v_mfma_f32_16x16x32_bf16 v[60:63], v[92:95], v[156:159], v[60:63]
    ds_read_b64_tr_b16 v[86:87], v8 offset:61056
    s_waitcnt lgkmcnt(8)
    v_mfma_f32_16x16x32_bf16 v[64:67], v[96:99], v[152:155], v[64:67]
    ds_read_b64_tr_b16 v[88:89], v8 offset:57504
    s_waitcnt vmcnt(15)
    v_mfma_f32_16x16x32_bf16 v[68:71], v[96:99], v[156:159], v[68:71]
    ds_read_b64_tr_b16 v[90:91], v8 offset:61088
    v_mfma_f32_16x16x32_bf16 v[16:19], v[100:103], v[160:163], v[16:19]
    ds_read_b64_tr_b16 v[92:93], v8 offset:57536
    buffer_load_dwordx4 a[168:171], v12, s[28:31], s21 offen offset:2048 sc1
    v_mfma_f32_16x16x32_bf16 v[20:23], v[100:103], v[164:167], v[20:23]
    ds_read_b64_tr_b16 v[94:95], v8 offset:61120
    s_waitcnt lgkmcnt(8)
    v_mfma_f32_16x16x32_bf16 v[24:27], v[72:75], v[160:163], v[24:27]
    ds_read_b64_tr_b16 v[96:97], v9 offset:0
    v_mfma_f32_16x16x32_bf16 v[28:31], v[72:75], v[164:167], v[28:31]
    ds_read_b64_tr_b16 v[98:99], v9 offset:3584
    v_mfma_f32_16x16x32_bf16 v[32:35], v[76:79], v[160:163], v[32:35]
    ds_read_b64_tr_b16 v[100:101], v9 offset:7168
    buffer_load_dwordx4 a[172:175], v12, s[28:31], s21 offen offset:3072 sc1
    v_mfma_f32_16x16x32_bf16 v[36:39], v[76:79], v[164:167], v[36:39]
    ds_read_b64_tr_b16 v[102:103], v9 offset:10752
    s_waitcnt lgkmcnt(8)
    v_mfma_f32_16x16x32_bf16 v[40:43], v[80:83], v[160:163], v[40:43]
    ds_read_b64_tr_b16 v[72:73], v9 offset:32
    v_mfma_f32_16x16x32_bf16 v[44:47], v[80:83], v[164:167], v[44:47]
    ds_read_b64_tr_b16 v[74:75], v9 offset:3616
    v_mfma_f32_16x16x32_bf16 v[48:51], v[84:87], v[160:163], v[48:51]
    ds_read_b64_tr_b16 v[76:77], v9 offset:7200
    s_add_u32 s21, s21, 4096
    buffer_load_dwordx4 a[176:179], v12, s[28:31], s21 offen offset:0 sc1
    v_mfma_f32_16x16x32_bf16 v[52:55], v[84:87], v[164:167], v[52:55]
    ds_read_b64_tr_b16 v[78:79], v9 offset:10784
    s_waitcnt lgkmcnt(8)
    v_mfma_f32_16x16x32_bf16 v[56:59], v[88:91], v[160:163], v[56:59]
    ds_read_b64_tr_b16 v[80:81], v9 offset:64
    buffer_load_dwordx4 a[180:183], v12, s[28:31], s21 offen offset:1024 sc1
    v_mfma_f32_16x16x32_bf16 v[60:63], v[88:91], v[164:167], v[60:63]
    ds_read_b64_tr_b16 v[82:83], v9 offset:3648
    v_mfma_f32_16x16x32_bf16 v[64:67], v[92:95], v[160:163], v[64:67]
    ds_read_b64_tr_b16 v[84:85], v9 offset:7232
    s_waitcnt vmcnt(12)
    v_mfma_f32_16x16x32_bf16 v[68:71], v[92:95], v[164:167], v[68:71]
    ds_read_b64_tr_b16 v[86:87], v9 offset:10816
    s_waitcnt lgkmcnt(8)
    v_mfma_f32_16x16x32_bf16 v[16:19], v[96:99], v[168:171], v[16:19]
    ds_read_b64_tr_b16 v[88:89], v9 offset:96
    v_mfma_f32_16x16x32_bf16 v[20:23], v[96:99], v[172:175], v[20:23]
    ds_read_b64_tr_b16 v[90:91], v9 offset:3680
    v_mfma_f32_16x16x32_bf16 v[16:19], v[100:103], v[176:179], v[16:19]
    ds_read_b64_tr_b16 v[92:93], v9 offset:7264
    v_mfma_f32_16x16x32_bf16 v[20:23], v[100:103], v[180:183], v[20:23]
    ds_read_b64_tr_b16 v[94:95], v9 offset:10848
    s_waitcnt lgkmcnt(8)
    v_mfma_f32_16x16x32_bf16 v[24:27], v[72:75], v[168:171], v[24:27]
    ds_read_b64_tr_b16 v[96:97], v9 offset:128
    v_mfma_f32_16x16x32_bf16 v[28:31], v[72:75], v[172:175], v[28:31]
    ds_read_b64_tr_b16 v[98:99], v9 offset:3712
    v_mfma_f32_16x16x32_bf16 v[24:27], v[76:79], v[176:179], v[24:27]
    ds_read_b64_tr_b16 v[100:101], v9 offset:7296
    v_pk_fma_f32 v[16:17], v[184:185], v[10:11], v[16:17] op_sel_hi:[1,0,1] neg_lo:[0,1,0] neg_hi:[0,1,0]
    v_pk_fma_f32 v[18:19], v[186:187], v[10:11], v[18:19] op_sel_hi:[1,0,1] neg_lo:[0,1,0] neg_hi:[0,1,0]
    v_pk_fma_f32 v[20:21], v[184:185], v[2:3], v[20:21] op_sel_hi:[1,0,1] neg_lo:[0,1,0] neg_hi:[0,1,0]
    v_pk_fma_f32 v[22:23], v[186:187], v[2:3], v[22:23] op_sel_hi:[1,0,1] neg_lo:[0,1,0] neg_hi:[0,1,0]
    v_mfma_f32_16x16x32_bf16 v[28:31], v[76:79], v[180:183], v[28:31]
    ds_read_b64_tr_b16 v[102:103], v9 offset:10880
    s_waitcnt lgkmcnt(8)
    v_cvt_pk_bf16_f32 v16, v16, v17
    v_cvt_pk_bf16_f32 v17, v18, v19
    v_cvt_pk_bf16_f32 v18, v20, v21
    v_cvt_pk_bf16_f32 v19, v22, v23
    v_mfma_f32_16x16x32_bf16 v[32:35], v[80:83], v[168:171], v[32:35]
    ds_read_b64_tr_b16 v[72:73], v9 offset:160
    v_pk_max_i16 v16, v16, 0
    v_pk_max_i16 v17, v17, 0
    v_pk_max_i16 v18, v18, 0
    v_pk_max_i16 v19, v19, 0
    v_mfma_f32_16x16x32_bf16 v[36:39], v[80:83], v[172:175], v[36:39]
    ds_read_b64_tr_b16 v[74:75], v9 offset:3744
    v_permlane16_swap_b32 v16, v18
    v_permlane16_swap_b32 v17, v19
    v_mfma_f32_16x16x32_bf16 v[32:35], v[84:87], v[176:179], v[32:35]
    ds_read_b64_tr_b16 v[76:77], v9 offset:7328
    v_pk_fma_f32 v[24:25], v[188:189], v[10:11], v[24:25] op_sel_hi:[1,0,1] neg_lo:[0,1,0] neg_hi:[0,1,0]
    v_pk_fma_f32 v[26:27], v[190:191], v[10:11], v[26:27] op_sel_hi:[1,0,1] neg_lo:[0,1,0] neg_hi:[0,1,0]
    buffer_store_dwordx4 v[16:19], v6, s[28:31], s64 offen offset:0 sc1
    v_pk_fma_f32 v[28:29], v[188:189], v[2:3], v[28:29] op_sel_hi:[1,0,1] neg_lo:[0,1,0] neg_hi:[0,1,0]
    v_mfma_f32_16x16x32_bf16 v[36:39], v[84:87], v[180:183], v[36:39]
    ds_read_b64_tr_b16 v[78:79], v9 offset:10912
    s_waitcnt lgkmcnt(8)
    v_pk_fma_f32 v[30:31], v[190:191], v[2:3], v[30:31] op_sel_hi:[1,0,1] neg_lo:[0,1,0] neg_hi:[0,1,0]
    v_cvt_pk_bf16_f32 v24, v24, v25
    v_cvt_pk_bf16_f32 v25, v26, v27
    v_cvt_pk_bf16_f32 v26, v28, v29
    v_mfma_f32_16x16x32_bf16 v[40:43], v[88:91], v[168:171], v[40:43]
    ds_read_b64_tr_b16 v[80:81], v9 offset:192
    v_cvt_pk_bf16_f32 v27, v30, v31
    v_pk_max_i16 v24, v24, 0
    v_pk_max_i16 v25, v25, 0
    v_pk_max_i16 v26, v26, 0
    v_mfma_f32_16x16x32_bf16 v[44:47], v[88:91], v[172:175], v[44:47]
    ds_read_b64_tr_b16 v[82:83], v9 offset:3776
    v_pk_max_i16 v27, v27, 0
    v_permlane16_swap_b32 v24, v26
    s_nop 0
    v_permlane16_swap_b32 v25, v27
    v_mfma_f32_16x16x32_bf16 v[40:43], v[92:95], v[176:179], v[40:43]
    ds_read_b64_tr_b16 v[84:85], v9 offset:7360
    v_pk_fma_f32 v[32:33], v[192:193], v[10:11], v[32:33] op_sel_hi:[1,0,1] neg_lo:[0,1,0] neg_hi:[0,1,0]
    v_pk_fma_f32 v[34:35], v[194:195], v[10:11], v[34:35] op_sel_hi:[1,0,1] neg_lo:[0,1,0] neg_hi:[0,1,0]
    buffer_store_dwordx4 v[24:27], v6, s[28:31], s64 offen offset:512 sc1
    v_pk_fma_f32 v[36:37], v[192:193], v[2:3], v[36:37] op_sel_hi:[1,0,1] neg_lo:[0,1,0] neg_hi:[0,1,0]
    v_mfma_f32_16x16x32_bf16 v[44:47], v[92:95], v[180:183], v[44:47]
    ds_read_b64_tr_b16 v[86:87], v9 offset:10944
    s_waitcnt lgkmcnt(8)
    v_pk_fma_f32 v[38:39], v[194:195], v[2:3], v[38:39] op_sel_hi:[1,0,1] neg_lo:[0,1,0] neg_hi:[0,1,0]
    v_cvt_pk_bf16_f32 v32, v32, v33
    v_cvt_pk_bf16_f32 v33, v34, v35
    v_cvt_pk_bf16_f32 v34, v36, v37
    v_mfma_f32_16x16x32_bf16 v[48:51], v[96:99], v[168:171], v[48:51]
    v_cvt_pk_bf16_f32 v35, v38, v39
    v_pk_max_i16 v32, v32, 0
    v_pk_max_i16 v33, v33, 0
    v_pk_max_i16 v34, v34, 0
    v_mfma_f32_16x16x32_bf16 v[52:55], v[96:99], v[172:175], v[52:55]
    v_pk_max_i16 v35, v35, 0
    v_permlane16_swap_b32 v32, v34
    s_nop 0
    v_permlane16_swap_b32 v33, v35
    v_mfma_f32_16x16x32_bf16 v[48:51], v[100:103], v[176:179], v[48:51]
    v_pk_fma_f32 v[40:41], v[196:197], v[10:11], v[40:41] op_sel_hi:[1,0,1] neg_lo:[0,1,0] neg_hi:[0,1,0]
    v_pk_fma_f32 v[42:43], v[198:199], v[10:11], v[42:43] op_sel_hi:[1,0,1] neg_lo:[0,1,0] neg_hi:[0,1,0]
    buffer_store_dwordx4 v[32:35], v6, s[28:31], s64 offen offset:1024 sc1
    v_pk_fma_f32 v[44:45], v[196:197], v[2:3], v[44:45] op_sel_hi:[1,0,1] neg_lo:[0,1,0] neg_hi:[0,1,0]
    v_mfma_f32_16x16x32_bf16 v[52:55], v[100:103], v[180:183], v[52:55]
    s_waitcnt lgkmcnt(4)
    v_pk_fma_f32 v[46:47], v[198:199], v[2:3], v[46:47] op_sel_hi:[1,0,1] neg_lo:[0,1,0] neg_hi:[0,1,0]
    v_cvt_pk_bf16_f32 v40, v40, v41
    v_cvt_pk_bf16_f32 v41, v42, v43
    v_cvt_pk_bf16_f32 v42, v44, v45
    v_mfma_f32_16x16x32_bf16 v[56:59], v[72:75], v[168:171], v[56:59]
    v_cvt_pk_bf16_f32 v43, v46, v47
    v_pk_max_i16 v40, v40, 0
    v_pk_max_i16 v41, v41, 0
    v_pk_max_i16 v42, v42, 0
    v_mfma_f32_16x16x32_bf16 v[60:63], v[72:75], v[172:175], v[60:63]
    v_pk_max_i16 v43, v43, 0
    v_permlane16_swap_b32 v40, v42
    s_nop 0
    v_permlane16_swap_b32 v41, v43
    v_mfma_f32_16x16x32_bf16 v[56:59], v[76:79], v[176:179], v[56:59]
    v_pk_fma_f32 v[48:49], v[200:201], v[10:11], v[48:49] op_sel_hi:[1,0,1] neg_lo:[0,1,0] neg_hi:[0,1,0]
    v_pk_fma_f32 v[50:51], v[202:203], v[10:11], v[50:51] op_sel_hi:[1,0,1] neg_lo:[0,1,0] neg_hi:[0,1,0]
    buffer_store_dwordx4 v[40:43], v6, s[28:31], s64 offen offset:1536 sc1
    v_pk_fma_f32 v[52:53], v[200:201], v[2:3], v[52:53] op_sel_hi:[1,0,1] neg_lo:[0,1,0] neg_hi:[0,1,0]
    v_mfma_f32_16x16x32_bf16 v[60:63], v[76:79], v[180:183], v[60:63]
    s_waitcnt lgkmcnt(0)
    v_pk_fma_f32 v[54:55], v[202:203], v[2:3], v[54:55] op_sel_hi:[1,0,1] neg_lo:[0,1,0] neg_hi:[0,1,0]
    v_cvt_pk_bf16_f32 v48, v48, v49
    v_cvt_pk_bf16_f32 v49, v50, v51
    v_cvt_pk_bf16_f32 v50, v52, v53
    v_mfma_f32_16x16x32_bf16 v[64:67], v[80:83], v[168:171], v[64:67]
    v_cvt_pk_bf16_f32 v51, v54, v55
    v_pk_max_i16 v48, v48, 0
    v_pk_max_i16 v49, v49, 0
    v_pk_max_i16 v50, v50, 0
    v_mfma_f32_16x16x32_bf16 v[68:71], v[80:83], v[172:175], v[68:71]
    v_pk_max_i16 v51, v51, 0
    v_permlane16_swap_b32 v48, v50
    s_nop 0
    v_permlane16_swap_b32 v49, v51
    v_mfma_f32_16x16x32_bf16 v[64:67], v[84:87], v[176:179], v[64:67]
    v_pk_fma_f32 v[56:57], v[204:205], v[10:11], v[56:57] op_sel_hi:[1,0,1] neg_lo:[0,1,0] neg_hi:[0,1,0]
    v_pk_fma_f32 v[58:59], v[206:207], v[10:11], v[58:59] op_sel_hi:[1,0,1] neg_lo:[0,1,0] neg_hi:[0,1,0]
    buffer_store_dwordx4 v[48:51], v6, s[28:31], s64 offen offset:2048 sc1
    v_pk_fma_f32 v[60:61], v[204:205], v[2:3], v[60:61] op_sel_hi:[1,0,1] neg_lo:[0,1,0] neg_hi:[0,1,0]
    v_mfma_f32_16x16x32_bf16 v[68:71], v[84:87], v[180:183], v[68:71]
    v_pk_fma_f32 v[62:63], v[206:207], v[2:3], v[62:63] op_sel_hi:[1,0,1] neg_lo:[0,1,0] neg_hi:[0,1,0]
    v_cvt_pk_bf16_f32 v56, v56, v57
    v_cvt_pk_bf16_f32 v57, v58, v59
    v_cvt_pk_bf16_f32 v58, v60, v61
    v_cvt_pk_bf16_f32 v59, v62, v63
    v_pk_max_i16 v56, v56, 0
    v_pk_max_i16 v57, v57, 0
    v_pk_max_i16 v58, v58, 0
    v_pk_max_i16 v59, v59, 0
    s_nop 0
    v_permlane16_swap_b32 v56, v58
    v_permlane16_swap_b32 v57, v59
    v_pk_fma_f32 v[64:65], v[208:209], v[10:11], v[64:65] op_sel_hi:[1,0,1] neg_lo:[0,1,0] neg_hi:[0,1,0]
    v_pk_fma_f32 v[66:67], v[210:211], v[10:11], v[66:67] op_sel_hi:[1,0,1] neg_lo:[0,1,0] neg_hi:[0,1,0]
    v_pk_fma_f32 v[68:69], v[208:209], v[2:3], v[68:69] op_sel_hi:[1,0,1] neg_lo:[0,1,0] neg_hi:[0,1,0]
    buffer_store_dwordx4 v[56:59], v6, s[28:31], s64 offen offset:2560 sc1
    v_pk_fma_f32 v[70:71], v[210:211], v[2:3], v[70:71] op_sel_hi:[1,0,1] neg_lo:[0,1,0] neg_hi:[0,1,0]
    v_cvt_pk_bf16_f32 v64, v64, v65
    v_cvt_pk_bf16_f32 v65, v66, v67
    v_cvt_pk_bf16_f32 v66, v68, v69
    v_cvt_pk_bf16_f32 v67, v70, v71
    v_pk_max_i16 v64, v64, 0
    v_pk_max_i16 v65, v65, 0
    v_pk_max_i16 v66, v66, 0
    v_pk_max_i16 v67, v67, 0
    s_nop 0
    v_permlane16_swap_b32 v64, v66
    v_permlane16_swap_b32 v65, v67
    buffer_store_dwordx4 v[64:67], v6, s[28:31], s65 offen offset:3072 sc1
    s_waitcnt vmcnt(0)
    v_mov_b32 v8, s24
    v_mov_b32 v9, s25
    v_mov_b32 v10, 0
    s_mov_b64 exec, 1
    buffer_store_dwordx2 v[8:9], v10, s[28:31], s66 offen sc1
    s_mov_b64 exec, -1
    buffer_load_dwordx4 a[184:187], v12, s[28:31], s21 offen offset:2048 sc1
    buffer_load_dwordx4 a[188:191], v12, s[28:31], s21 offen offset:3072 sc1
    s_add_u32 s21, s21, 4096
    buffer_load_dwordx4 a[192:195], v12, s[28:31], s21 offen offset:0 sc1
    buffer_load_dwordx4 a[196:199], v12, s[28:31], s21 offen offset:1024 sc1
    buffer_load_dwordx4 a[200:203], v12, s[28:31], s21 offen offset:2048 sc1
    buffer_load_dwordx4 a[204:207], v12, s[28:31], s21 offen offset:3072 sc1
    s_add_u32 s21, s21, 4096
    buffer_load_dwordx4 a[208:211], v12, s[28:31], s21 offen offset:0 sc1
    buffer_load_dwordx4 a[212:215], v12, s[28:31], s21 offen offset:1024 sc1
    buffer_load_dwordx4 a[216:219], v12, s[28:31], s21 offen offset:2048 sc1
    buffer_load_dwordx4 a[220:223], v12, s[28:31], s21 offen offset:3072 sc1
    s_add_u32 s21, s21, 4096
    buffer_load_dwordx4 a[224:227], v12, s[28:31], s21 offen offset:0 sc1
    buffer_load_dwordx4 a[228:231], v12, s[28:31], s21 offen offset:1024 sc1
    buffer_load_dwordx4 a[232:235], v12, s[28:31], s21 offen offset:2048 sc1
    buffer_load_dwordx4 a[236:239], v12, s[28:31], s21 offen offset:3072 sc1
    s_add_u32 s21, s21, 4096
    buffer_load_dwordx4 a[240:243], v13, s[28:31], s21 offen offset:0 sc1
    buffer_load_dwordx4 a[244:247], v13, s[28:31], s21 offen offset:1024 sc1
    buffer_load_dwordx4 a[248:251], v13, s[28:31], s21 offen offset:2048 sc1
    buffer_load_dwordx4 a[252:255], v13, s[28:31], s21 offen offset:3072 sc1
    s_add_u32 s21, s21, 4096
    buffer_load_dwordx4 v[232:235], v13, s[28:31], s21 offen offset:0 sc1
    buffer_load_dwordx4 v[236:239], v13, s[28:31], s21 offen offset:1024 sc1
    buffer_load_dwordx4 v[240:243], v13, s[28:31], s21 offen offset:2048 sc1
    buffer_load_dwordx4 v[244:247], v13, s[28:31], s21 offen offset:3072 sc1
    s_add_u32 s21, s21, 4096
    buffer_load_dwordx4 v[248:251], v13, s[28:31], s21 offen offset:0 sc1
    buffer_load_dwordx4 v[252:255], v13, s[28:31], s21 offen offset:1024 sc1
    s_lshl_b32 s46, s19, 2
    s_add_u32 s46, s46, s3
    s_mul_i32 s49, s46, 2560
    s_add_u32 s49, s49, 8388608
    v_lshrrev_b32 v2, 4, v1
    v_and_b32 v3, 15, v1
    s_mul_i32 s47, s46, 20480
    s_mul_i32 s48, s20, 2560
    s_add_u32 s47, s47, s48
    s_add_u32 s47, s47, 4194304
    v_lshrrev_b32 v4, 1, v2
    v_lshlrev_b32 v4, 8, v4
    v_lshl_add_u32 v4, v3, 4, v4
    v_and_b32 v5, 1, v2
    v_lshl_add_u32 v4, v5, 3, v4
    s_lshr_b32 s40, s19, 1
    s_lshl_b32 s40, s40, 13
    s_and_b32 s41, s19, 1
    s_lshl_b32 s41, s41, 8
    s_add_u32 s40, s40, s41
    s_add_u32 s40, s40, 26345472
    v_lshrrev_b32 v5, 1, v1
    v_min_u32 v5, 4, v5
    v_lshl_add_u32 v5, s3, 2, v5
    v_min_u32 v5, 15, v5
    v_lshlrev_b32 v5, 9, v5
    v_and_b32 v6, 1, v1
    v_lshl_add_u32 v5, v6, 7, v5
    s_mul_i32 s48, s3, 2816
    s_add_u32 s48, s48, 61440
    s_movk_i32 s51, 176
    s_mov_b32 s50, 40960
    v_add_u32 v6, 0, v1
    v_mul_u32_u24 v7, 6554, v6
    v_lshrrev_b32 v7, 16, v7
    v_mul_u32_u24 v8, 10, v7
    v_sub_u32 v8, v6, v8
    v_lshlrev_b32 v8, 4, v8
    v_mad_u32_u24 v220, v7, s51, v8
    v_add_u32 v220, s48, v220
    v_mad_u32_u24 v223, v7, s50, v8
    v_add_u32 v6, 64, v1
    v_mul_u32_u24 v7, 6554, v6
    v_lshrrev_b32 v7, 16, v7
    v_mul_u32_u24 v8, 10, v7
    v_sub_u32 v8, v6, v8
    v_lshlrev_b32 v8, 4, v8
    v_mad_u32_u24 v221, v7, s51, v8
    v_add_u32 v221, s48, v221
    v_mad_u32_u24 v224, v7, s50, v8
    v_add_u32 v6, 128, v1
    v_mul_u32_u24 v7, 6554, v6
    v_lshrrev_b32 v7, 16, v7
    v_mul_u32_u24 v8, 10, v7
    v_sub_u32 v8, v6, v8
    v_lshlrev_b32 v8, 4, v8
    v_mad_u32_u24 v222, v7, s51, v8
    v_add_u32 v222, s48, v222
    v_mad_u32_u24 v225, v7, s50, v8
    v_cmp_gt_u32 vcc, 32, v1
    v_mov_b32 v6, 1073741824
    s_nop 0
    v_cndmask_b32 v225, v6, v225, vcc
    v_mul_u32_u24 v226, 176, v3
    v_lshl_add_u32 v226, v2, 3, v226
    v_add_u32 v226, s48, v226
    s_barrier
    s_mov_b32 s59, 0
L_poll3:
L_poll3_go:
    buffer_load_dwordx2 v[6:7], v5, s[28:31], s40 offen sc1
    s_add_u32 s59, s59, 1
    s_cmp_gt_u32 s59, 200000
    s_cbranch_scc1 L_poll3_out
L_poll3_chk:
    s_waitcnt vmcnt(0)
    v_cmp_ne_u64 vcc, s[24:25], v[6:7]
    s_cbranch_vccnz L_poll3
L_poll3_out:
    s_add_u32 s45, s3, 1
    s_and_b32 s45, s45, 3
    s_lshl_b32 s46, s19, 2
    s_add_u32 s45, s45, s46
    s_mul_i32 s45, s45, 55296
    s_add_u32 s45, s45, s22
    buffer_load_dwordx4 v[56:59], v12, s[28:31], s45 offen offset:0 sc1
    buffer_load_dwordx4 v[60:63], v12, s[28:31], s45 offen offset:1024 sc1
    buffer_load_dwordx4 v[64:67], v12, s[28:31], s45 offen offset:2048 sc1
    buffer_load_dwordx4 v[68:71], v12, s[28:31], s45 offen offset:3072 sc1
    s_add_u32 s45, s45, 4096
    buffer_load_dwordx4 v[72:75], v12, s[28:31], s45 offen offset:0 sc1
    buffer_load_dwordx4 v[76:79], v12, s[28:31], s45 offen offset:1024 sc1
    buffer_load_dwordx4 v[80:83], v12, s[28:31], s45 offen offset:2048 sc1
    buffer_load_dwordx4 v[84:87], v12, s[28:31], s45 offen offset:3072 sc1
    s_add_u32 s45, s45, 4096
    buffer_load_dwordx4 v[88:91], v12, s[28:31], s45 offen offset:0 sc1
    buffer_load_dwordx4 v[92:95], v12, s[28:31], s45 offen offset:1024 sc1
    s_waitcnt vmcnt(9)
    v_mfma_f32_16x16x32_bf16 v[16:19], a[0:3], v[56:59], 0
    buffer_load_dwordx4 v[96:99], v12, s[28:31], s45 offen offset:2048 sc1
    v_mfma_f32_16x16x32_bf16 v[20:23], a[4:7], v[56:59], 0
    v_mfma_f32_16x16x32_bf16 v[24:27], a[8:11], v[56:59], 0
    v_mfma_f32_16x16x32_bf16 v[28:31], a[12:15], v[56:59], 0
    v_mfma_f32_16x16x32_bf16 v[32:35], a[16:19], v[56:59], 0
    s_waitcnt vmcnt(9)
    v_mfma_f32_16x16x32_bf16 v[16:19], a[20:23], v[60:63], v[16:19]
    buffer_load_dwordx4 v[100:103], v12, s[28:31], s45 offen offset:3072 sc1
    v_mfma_f32_16x16x32_bf16 v[20:23], a[24:27], v[60:63], v[20:23]
    v_mfma_f32_16x16x32_bf16 v[24:27], a[28:31], v[60:63], v[24:27]
    v_mfma_f32_16x16x32_bf16 v[28:31], a[32:35], v[60:63], v[28:31]
    v_mfma_f32_16x16x32_bf16 v[32:35], a[36:39], v[60:63], v[32:35]
    s_waitcnt vmcnt(9)
    v_mfma_f32_16x16x32_bf16 v[16:19], a[40:43], v[64:67], v[16:19]
    s_add_u32 s45, s45, 4096
    buffer_load_dwordx4 v[104:107], v13, s[28:31], s45 offen offset:0 sc1
    v_mfma_f32_16x16x32_bf16 v[20:23], a[44:47], v[64:67], v[20:23]
    v_mfma_f32_16x16x32_bf16 v[24:27], a[48:51], v[64:67], v[24:27]
    v_mfma_f32_16x16x32_bf16 v[28:31], a[52:55], v[64:67], v[28:31]
    v_mfma_f32_16x16x32_bf16 v[32:35], a[56:59], v[64:67], v[32:35]
    s_waitcnt vmcnt(9)
    v_mfma_f32_16x16x32_bf16 v[16:19], a[60:63], v[68:71], v[16:19]
    buffer_load_dwordx4 v[108:111], v13, s[28:31], s45 offen offset:1024 sc1
    v_mfma_f32_16x16x32_bf16 v[20:23], a[64:67], v[68:71], v[20:23]
    v_mfma_f32_16x16x32_bf16 v[24:27], a[68:71], v[68:71], v[24:27]
    v_mfma_f32_16x16x32_bf16 v[28:31], a[72:75], v[68:71], v[28:31]
    v_mfma_f32_16x16x32_bf16 v[32:35], a[76:79], v[68:71], v[32:35]
    s_waitcnt vmcnt(9)
    v_mfma_f32_16x16x32_bf16 v[16:19], a[80:83], v[72:75], v[16:19]
    s_add_u32 s45, s3, 2
    s_and_b32 s45, s45, 3
    s_lshl_b32 s46, s19, 2
    s_add_u32 s45, s45, s46
    s_mul_i32 s45, s45, 55296
    s_add_u32 s45, s45, s22
    buffer_load_dwordx4 v[112:115], v12, s[28:31], s45 offen offset:0 sc1
    v_mfma_f32_16x16x32_bf16 v[20:23], a[84:87], v[72:75], v[20:23]
    v_mfma_f32_16x16x32_bf16 v[24:27], a[88:91], v[72:75], v[24:27]
    v_mfma_f32_16x16x32_bf16 v[28:31], a[92:95], v[72:75], v[28:31]
    v_mfma_f32_16x16x32_bf16 v[32:35], a[96:99], v[72:75], v[32:35]
    s_waitcnt vmcnt(9)
    v_mfma_f32_16x16x32_bf16 v[16:19], a[100:103], v[76:79], v[16:19]
    buffer_load_dwordx4 v[116:119], v12, s[28:31], s45 offen offset:1024 sc1
    v_mfma_f32_16x16x32_bf16 v[20:23], a[104:107], v[76:79], v[20:23]
    v_mfma_f32_16x16x32_bf16 v[24:27], a[108:111], v[76:79], v[24:27]
    v_mfma_f32_16x16x32_bf16 v[28:31], a[112:115], v[76:79], v[28:31]
    v_mfma_f32_16x16x32_bf16 v[32:35], a[116:119], v[76:79], v[32:35]
    s_waitcnt vmcnt(9)
    v_mfma_f32_16x16x32_bf16 v[16:19], a[120:123], v[80:83], v[16:19]
    buffer_load_dwordx4 v[120:123], v12, s[28:31], s45 offen offset:2048 sc1
    v_mfma_f32_16x16x32_bf16 v[20:23], a[124:127], v[80:83], v[20:23]
    v_mfma_f32_16x16x32_bf16 v[24:27], a[128:131], v[80:83], v[24:27]
    v_mfma_f32_16x16x32_bf16 v[28:31], a[132:135], v[80:83], v[28:31]
    v_mfma_f32_16x16x32_bf16 v[32:35], a[136:139], v[80:83], v[32:35]
    s_waitcnt vmcnt(9)
    v_mfma_f32_16x16x32_bf16 v[16:19], a[140:143], v[84:87], v[16:19]
    buffer_load_dwordx4 v[124:127], v12, s[28:31], s45 offen offset:3072 sc1
    v_mfma_f32_16x16x32_bf16 v[20:23], a[144:147], v[84:87], v[20:23]
    v_mfma_f32_16x16x32_bf16 v[24:27], a[148:151], v[84:87], v[24:27]
    v_mfma_f32_16x16x32_bf16 v[28:31], a[152:155], v[84:87], v[28:31]
    v_mfma_f32_16x16x32_bf16 v[32:35], a[156:159], v[84:87], v[32:35]
    s_waitcnt vmcnt(9)
    v_mfma_f32_16x16x32_bf16 v[16:19], a[160:163], v[88:91], v[16:19]
    s_add_u32 s45, s45, 4096
    buffer_load_dwordx4 v[128:131], v12, s[28:31], s45 offen offset:0 sc1
    v_mfma_f32_16x16x32_bf16 v[20:23], a[164:167], v[88:91], v[20:23]
    v_mfma_f32_16x16x32_bf16 v[24:27], a[168:171], v[88:91], v[24:27]
    v_mfma_f32_16x16x32_bf16 v[28:31], a[172:175], v[88:91], v[28:31]
    v_mfma_f32_16x16x32_bf16 v[32:35], a[176:179], v[88:91], v[32:35]
    s_waitcnt vmcnt(9)
    v_mfma_f32_16x16x32_bf16 v[16:19], a[180:183], v[92:95], v[16:19]
    buffer_load_dwordx4 v[132:135], v12, s[28:31], s45 offen offset:1024 sc1
    v_mfma_f32_16x16x32_bf16 v[20:23], a[184:187], v[92:95], v[20:23]
    v_mfma_f32_16x16x32_bf16 v[24:27], a[188:191], v[92:95], v[24:27]
    v_mfma_f32_16x16x32_bf16 v[28:31], a[192:195], v[92:95], v[28:31]
    v_mfma_f32_16x16x32_bf16 v[32:35], a[196:199], v[92:95], v[32:35]
    s_waitcnt vmcnt(9)
    v_mfma_f32_16x16x32_bf16 v[16:19], a[200:203], v[96:99], v[16:19]
    buffer_load_dwordx4 v[136:139], v12, s[28:31], s45 offen offset:2048 sc1
    v_mfma_f32_16x16x32_bf16 v[20:23], a[204:207], v[96:99], v[20:23]
    v_mfma_f32_16x16x32_bf16 v[24:27], a[208:211], v[96:99], v[24:27]
    v_mfma_f32_16x16x32_bf16 v[28:31], a[212:215], v[96:99], v[28:31]
    v_mfma_f32_16x16x32_bf16 v[32:35], a[216:219], v[96:99], v[32:35]
    s_waitcnt vmcnt(9)
    v_mfma_f32_16x16x32_bf16 v[16:19], a[220:223], v[100:103], v[16:19]
    buffer_load_dwordx4 v[140:143], v12, s[28:31], s45 offen offset:3072 sc1
    v_mfma_f32_16x16x32_bf16 v[20:23], a[224:227], v[100:103], v[20:23]
    v_mfma_f32_16x16x32_bf16 v[24:27], a[228:231], v[100:103], v[24:27]
    v_mfma_f32_16x16x32_bf16 v[28:31], a[232:235], v[100:103], v[28:31]
    v_mfma_f32_16x16x32_bf16 v[32:35], a[236:239], v[100:103], v[32:35]
    s_waitcnt vmcnt(9)
    v_mfma_f32_16x16x32_bf16 v[16:19], a[240:243], v[104:107], v[16:19]
    s_add_u32 s45, s45, 4096
    buffer_load_dwordx4 v[144:147], v12, s[28:31], s45 offen offset:0 sc1
    v_mfma_f32_16x16x32_bf16 v[20:23], a[244:247], v[104:107], v[20:23]
    v_mfma_f32_16x16x32_bf16 v[24:27], a[248:251], v[104:107], v[24:27]
    v_mfma_f32_16x16x32_bf16 v[28:31], a[252:255], v[104:107], v[28:31]
    v_mfma_f32_16x16x32_bf16 v[32:35], v[232:235], v[104:107], v[32:35]
    s_waitcnt vmcnt(9)
    v_mfma_f32_16x16x32_bf16 v[16:19], v[236:239], v[108:111], v[16:19]
    buffer_load_dwordx4 v[148:151], v12, s[28:31], s45 offen offset:1024 sc1
    v_mfma_f32_16x16x32_bf16 v[20:23], v[240:243], v[108:111], v[20:23]
    v_mfma_f32_16x16x32_bf16 v[24:27], v[244:247], v[108:111], v[24:27]
    v_mfma_f32_16x16x32_bf16 v[28:31], v[248:251], v[108:111], v[28:31]
    v_mfma_f32_16x16x32_bf16 v[32:35], v[252:255], v[108:111], v[32:35]
    s_waitcnt vmcnt(9)
    v_mfma_f32_16x16x32_bf16 v[36:39], a[0:3], v[112:115], 0
    buffer_load_dwordx4 v[152:155], v12, s[28:31], s45 offen offset:2048 sc1
    v_mfma_f32_16x16x32_bf16 v[40:43], a[4:7], v[112:115], 0
    v_mfma_f32_16x16x32_bf16 v[44:47], a[8:11], v[112:115], 0
    v_mfma_f32_16x16x32_bf16 v[48:51], a[12:15], v[112:115], 0
    v_mfma_f32_16x16x32_bf16 v[52:55], a[16:19], v[112:115], 0
    s_waitcnt vmcnt(9)
    v_mfma_f32_16x16x32_bf16 v[36:39], a[20:23], v[116:119], v[36:39]
    buffer_load_dwordx4 v[156:159], v12, s[28:31], s45 offen offset:3072 sc1
    v_mfma_f32_16x16x32_bf16 v[40:43], a[24:27], v[116:119], v[40:43]
    v_mfma_f32_16x16x32_bf16 v[44:47], a[28:31], v[116:119], v[44:47]
    v_mfma_f32_16x16x32_bf16 v[48:51], a[32:35], v[116:119], v[48:51]
    v_mfma_f32_16x16x32_bf16 v[52:55], a[36:39], v[116:119], v[52:55]
    s_waitcnt vmcnt(9)
    v_mfma_f32_16x16x32_bf16 v[36:39], a[40:43], v[120:123], v[36:39]
    s_add_u32 s45, s45, 4096
    buffer_load_dwordx4 v[160:163], v13, s[28:31], s45 offen offset:0 sc1
    s_add_u32 s48, s3, 1
    s_and_b32 s48, s48, 3
    s_mul_i32 s48, s48, 15360
    v_mfma_f32_16x16x32_bf16 v[40:43], a[44:47], v[120:123], v[40:43]
    s_add_u32 s48, s48, 0
    v_add_u32 v9, s48, v12
    ds_write_b128 v9, v[16:19] offset:0
    v_mfma_f32_16x16x32_bf16 v[44:47], a[48:51], v[120:123], v[44:47]
    ds_write_b128 v9, v[20:23] offset:1024
    v_mfma_f32_16x16x32_bf16 v[48:51], a[52:55], v[120:123], v[48:51]
    ds_write_b128 v9, v[24:27] offset:2048
    v_mfma_f32_16x16x32_bf16 v[52:55], a[56:59], v[120:123], v[52:55]
    s_waitcnt vmcnt(9)
    v_mfma_f32_16x16x32_bf16 v[36:39], a[60:63], v[124:127], v[36:39]
    buffer_load_dwordx4 v[164:167], v13, s[28:31], s45 offen offset:1024 sc1
    v_mfma_f32_16x16x32_bf16 v[40:43], a[64:67], v[124:127], v[40:43]
    ds_write_b128 v9, v[28:31] offset:3072
    v_mfma_f32_16x16x32_bf16 v[44:47], a[68:71], v[124:127], v[44:47]
    ds_write_b128 v9, v[32:35] offset:4096
    v_mfma_f32_16x16x32_bf16 v[48:51], a[72:75], v[124:127], v[48:51]
    v_mfma_f32_16x16x32_bf16 v[52:55], a[76:79], v[124:127], v[52:55]
    s_waitcnt vmcnt(9)
    v_mfma_f32_16x16x32_bf16 v[36:39], a[80:83], v[128:131], v[36:39]
    s_add_u32 s45, s3, 3
    s_and_b32 s45, s45, 3
    s_lshl_b32 s46, s19, 2
    s_add_u32 s45, s45, s46
    s_mul_i32 s45, s45, 55296
    s_add_u32 s45, s45, s22
    buffer_load_dwordx4 v[168:171], v12, s[28:31], s45 offen offset:0 sc1
    v_mfma_f32_16x16x32_bf16 v[40:43], a[84:87], v[128:131], v[40:43]
    v_mfma_f32_16x16x32_bf16 v[44:47], a[88:91], v[128:131], v[44:47]
    v_mfma_f32_16x16x32_bf16 v[48:51], a[92:95], v[128:131], v[48:51]
    v_mfma_f32_16x16x32_bf16 v[52:55], a[96:99], v[128:131], v[52:55]
    s_waitcnt vmcnt(9)
    v_mfma_f32_16x16x32_bf16 v[36:39], a[100:103], v[132:135], v[36:39]
    buffer_load_dwordx4 v[172:175], v12, s[28:31], s45 offen offset:1024 sc1
    v_mfma_f32_16x16x32_bf16 v[40:43], a[104:107], v[132:135], v[40:43]
    buffer_load_dwordx2 v[200:201], v14, s[28:31], s49 offen offset:0 sc1
    buffer_load_dwordx2 v[202:203], v14, s[28:31], s49 offen offset:128 sc1
    v_mfma_f32_16x16x32_bf16 v[44:47], a[108:111], v[132:135], v[44:47]
    buffer_load_dwordx2 v[204:205], v14, s[28:31], s49 offen offset:256 sc1
    buffer_load_dwordx2 v[206:207], v14, s[28:31], s49 offen offset:384 sc1
    v_mfma_f32_16x16x32_bf16 v[48:51], a[112:115], v[132:135], v[48:51]
    buffer_load_dwordx2 v[208:209], v14, s[28:31], s49 offen offset:512 sc1
    v_mfma_f32_16x16x32_bf16 v[52:55], a[116:119], v[132:135], v[52:55]
    s_waitcnt vmcnt(14)
    v_mfma_f32_16x16x32_bf16 v[36:39], a[120:123], v[136:139], v[36:39]
    buffer_load_dwordx4 v[176:179], v12, s[28:31], s45 offen offset:2048 sc1
    v_mfma_f32_16x16x32_bf16 v[40:43], a[124:127], v[136:139], v[40:43]
    v_mfma_f32_16x16x32_bf16 v[44:47], a[128:131], v[136:139], v[44:47]
    v_mfma_f32_16x16x32_bf16 v[48:51], a[132:135], v[136:139], v[48:51]
    v_mfma_f32_16x16x32_bf16 v[52:55], a[136:139], v[136:139], v[52:55]
    s_waitcnt vmcnt(14)
    v_mfma_f32_16x16x32_bf16 v[36:39], a[140:143], v[140:143], v[36:39]
    buffer_load_dwordx4 v[180:183], v12, s[28:31], s45 offen offset:3072 sc1
    v_mfma_f32_16x16x32_bf16 v[40:43], a[144:147], v[140:143], v[40:43]
    v_mfma_f32_16x16x32_bf16 v[44:47], a[148:151], v[140:143], v[44:47]
    v_mfma_f32_16x16x32_bf16 v[48:51], a[152:155], v[140:143], v[48:51]
    v_mfma_f32_16x16x32_bf16 v[52:55], a[156:159], v[140:143], v[52:55]
    s_waitcnt vmcnt(14)
    v_mfma_f32_16x16x32_bf16 v[36:39], a[160:163], v[144:147], v[36:39]
    s_add_u32 s45, s45, 4096
    buffer_load_dwordx4 v[184:187], v12, s[28:31], s45 offen offset:0 sc1
    v_mfma_f32_16x16x32_bf16 v[40:43], a[164:167], v[144:147], v[40:43]
    v_mfma_f32_16x16x32_bf16 v[44:47], a[168:171], v[144:147], v[44:47]
    v_mfma_f32_16x16x32_bf16 v[48:51], a[172:175], v[144:147], v[48:51]
    v_mfma_f32_16x16x32_bf16 v[52:55], a[176:179], v[144:147], v[52:55]
    s_waitcnt vmcnt(14)
    v_mfma_f32_16x16x32_bf16 v[36:39], a[180:183], v[148:151], v[36:39]
    buffer_load_dwordx4 v[188:191], v12, s[28:31], s45 offen offset:1024 sc1
    v_mfma_f32_16x16x32_bf16 v[40:43], a[184:187], v[148:151], v[40:43]
    v_mfma_f32_16x16x32_bf16 v[44:47], a[188:191], v[148:151], v[44:47]
    v_mfma_f32_16x16x32_bf16 v[48:51], a[192:195], v[148:151], v[48:51]
    v_mfma_f32_16x16x32_bf16 v[52:55], a[196:199], v[148:151], v[52:55]
    s_waitcnt vmcnt(14)
    v_mfma_f32_16x16x32_bf16 v[36:39], a[200:203], v[152:155], v[36:39]
    buffer_load_dwordx4 v[192:195], v12, s[28:31], s45 offen offset:2048 sc1
    v_mfma_f32_16x16x32_bf16 v[40:43], a[204:207], v[152:155], v[40:43]
    v_mfma_f32_16x16x32_bf16 v[44:47], a[208:211], v[152:155], v[44:47]
    v_mfma_f32_16x16x32_bf16 v[48:51], a[212:215], v[152:155], v[48:51]
    v_mfma_f32_16x16x32_bf16 v[52:55], a[216:219], v[152:155], v[52:55]
    s_waitcnt vmcnt(14)
    v_mfma_f32_16x16x32_bf16 v[36:39], a[220:223], v[156:159], v[36:39]
    buffer_load_dwordx4 v[196:199], v12, s[28:31], s45 offen offset:3072 sc1
    v_mfma_f32_16x16x32_bf16 v[40:43], a[224:227], v[156:159], v[40:43]
    v_mfma_f32_16x16x32_bf16 v[44:47], a[228:231], v[156:159], v[44:47]
    v_mfma_f32_16x16x32_bf16 v[48:51], a[232:235], v[156:159], v[48:51]
    v_mfma_f32_16x16x32_bf16 v[52:55], a[236:239], v[156:159], v[52:55]
    s_waitcnt vmcnt(14)
    v_mfma_f32_16x16x32_bf16 v[36:39], a[240:243], v[160:163], v[36:39]
    s_add_u32 s45, s45, 4096
    buffer_load_dwordx4 v[56:59], v12, s[28:31], s45 offen offset:0 sc1
    v_mfma_f32_16x16x32_bf16 v[40:43], a[244:247], v[160:163], v[40:43]
    v_mfma_f32_16x16x32_bf16 v[44:47], a[248:251], v[160:163], v[44:47]
    v_mfma_f32_16x16x32_bf16 v[48:51], a[252:255], v[160:163], v[48:51]
    v_mfma_f32_16x16x32_bf16 v[52:55], v[232:235], v[160:163], v[52:55]
    s_waitcnt vmcnt(14)
    v_mfma_f32_16x16x32_bf16 v[36:39], v[236:239], v[164:167], v[36:39]
    buffer_load_dwordx4 v[60:63], v12, s[28:31], s45 offen offset:1024 sc1
    v_mfma_f32_16x16x32_bf16 v[40:43], v[240:243], v[164:167], v[40:43]
    v_mfma_f32_16x16x32_bf16 v[44:47], v[244:247], v[164:167], v[44:47]
    v_mfma_f32_16x16x32_bf16 v[48:51], v[248:251], v[164:167], v[48:51]
    v_mfma_f32_16x16x32_bf16 v[52:55], v[252:255], v[164:167], v[52:55]
    s_waitcnt vmcnt(14)
    v_mfma_f32_16x16x32_bf16 v[16:19], a[0:3], v[168:171], 0
    buffer_load_dwordx4 v[64:67], v12, s[28:31], s45 offen offset:2048 sc1
    v_mfma_f32_16x16x32_bf16 v[20:23], a[4:7], v[168:171], 0
    v_mfma_f32_16x16x32_bf16 v[24:27], a[8:11], v[168:171], 0
    v_mfma_f32_16x16x32_bf16 v[28:31], a[12:15], v[168:171], 0
    v_mfma_f32_16x16x32_bf16 v[32:35], a[16:19], v[168:171], 0
    s_waitcnt vmcnt(14)
    v_mfma_f32_16x16x32_bf16 v[16:19], a[20:23], v[172:175], v[16:19]
    buffer_load_dwordx4 v[68:71], v12, s[28:31], s45 offen offset:3072 sc1
    v_mfma_f32_16x16x32_bf16 v[20:23], a[24:27], v[172:175], v[20:23]
    v_mfma_f32_16x16x32_bf16 v[24:27], a[28:31], v[172:175], v[24:27]
    v_mfma_f32_16x16x32_bf16 v[28:31], a[32:35], v[172:175], v[28:31]
    v_mfma_f32_16x16x32_bf16 v[32:35], a[36:39], v[172:175], v[32:35]
    s_waitcnt vmcnt(9)
    v_mfma_f32_16x16x32_bf16 v[16:19], a[40:43], v[176:179], v[16:19]
    s_add_u32 s45, s45, 4096
    buffer_load_dwordx4 v[72:75], v13, s[28:31], s45 offen offset:0 sc1
    s_add_u32 s48, s3, 2
    s_and_b32 s48, s48, 3
    s_mul_i32 s48, s48, 15360
    v_mfma_f32_16x16x32_bf16 v[20:23], a[44:47], v[176:179], v[20:23]
    s_add_u32 s48, s48, 5120
    v_add_u32 v9, s48, v12
    ds_write_b128 v9, v[36:39] offset:0
    v_mfma_f32_16x16x32_bf16 v[24:27], a[48:51], v[176:179], v[24:27]
    ds_write_b128 v9, v[40:43] offset:1024
    v_mfma_f32_16x16x32_bf16 v[28:31], a[52:55], v[176:179], v[28:31]
    ds_write_b128 v9, v[44:47] offset:2048
    v_mfma_f32_16x16x32_bf16 v[32:35], a[56:59], v[176:179], v[32:35]
    s_waitcnt vmcnt(9)
    v_mfma_f32_16x16x32_bf16 v[16:19], a[60:63], v[180:183], v[16:19]
    buffer_load_dwordx4 v[76:79], v13, s[28:31], s45 offen offset:1024 sc1
    v_mfma_f32_16x16x32_bf16 v[20:23], a[64:67], v[180:183], v[20:23]
    ds_write_b128 v9, v[48:51] offset:3072
    v_mfma_f32_16x16x32_bf16 v[24:27], a[68:71], v[180:183], v[24:27]
    ds_write_b128 v9, v[52:55] offset:4096
    v_mfma_f32_16x16x32_bf16 v[28:31], a[72:75], v[180:183], v[28:31]
    v_mfma_f32_16x16x32_bf16 v[32:35], a[76:79], v[180:183], v[32:35]
    s_waitcnt vmcnt(9)
    v_mfma_f32_16x16x32_bf16 v[16:19], a[80:83], v[184:187], v[16:19]
    s_add_u32 s45, s3, 4
    s_and_b32 s45, s45, 3
    s_lshl_b32 s46, s19, 2
    s_add_u32 s45, s45, s46
    s_mul_i32 s45, s45, 55296
    s_add_u32 s45, s45, s22
    buffer_load_dwordx4 v[80:83], v12, s[28:31], s45 offen offset:0 sc1
    v_mfma_f32_16x16x32_bf16 v[20:23], a[84:87], v[184:187], v[20:23]
    v_mfma_f32_16x16x32_bf16 v[24:27], a[88:91], v[184:187], v[24:27]
    v_mfma_f32_16x16x32_bf16 v[28:31], a[92:95], v[184:187], v[28:31]
    v_mfma_f32_16x16x32_bf16 v[32:35], a[96:99], v[184:187], v[32:35]
    s_waitcnt vmcnt(9)
    v_mfma_f32_16x16x32_bf16 v[16:19], a[100:103], v[188:191], v[16:19]
    buffer_load_dwordx4 v[84:87], v12, s[28:31], s45 offen offset:1024 sc1
    v_mfma_f32_16x16x32_bf16 v[20:23], a[104:107], v[188:191], v[20:23]
    buffer_load_dwordx2 v[210:211], v4, s[28:31], s47 offen offset:0 sc1
    buffer_load_dwordx2 v[212:213], v4, s[28:31], s47 offen offset:512 sc1
    v_mfma_f32_16x16x32_bf16 v[24:27], a[108:111], v[188:191], v[24:27]
    buffer_load_dwordx2 v[214:215], v4, s[28:31], s47 offen offset:1024 sc1
    buffer_load_dwordx2 v[216:217], v4, s[28:31], s47 offen offset:1536 sc1
    v_mfma_f32_16x16x32_bf16 v[28:31], a[112:115], v[188:191], v[28:31]
    buffer_load_dwordx2 v[218:219], v4, s[28:31], s47 offen offset:2048 sc1
    s_waitcnt vmcnt(19)
    v_mfma_f32_16x16x32_bf16 v[32:35], a[116:119], v[188:191], v[32:35]
    s_waitcnt vmcnt(14)
    v_mfma_f32_16x16x32_bf16 v[16:19], a[120:123], v[192:195], v[16:19]
    buffer_load_dwordx4 v[88:91], v12, s[28:31], s45 offen offset:2048 sc1
    v_mfma_f32_16x16x32_bf16 v[20:23], a[124:127], v[192:195], v[20:23]
    v_add_f32 v200, v200, v202
    v_add_f32 v204, v204, v206
    v_mfma_f32_16x16x32_bf16 v[24:27], a[128:131], v[192:195], v[24:27]
    v_add_f32 v201, v201, v203
    v_add_f32 v205, v205, v207
    v_mfma_f32_16x16x32_bf16 v[28:31], a[132:135], v[192:195], v[28:31]
    v_add_f32 v200, v200, v208
    v_add_f32 v201, v201, v209
    v_mfma_f32_16x16x32_bf16 v[32:35], a[136:139], v[192:195], v[32:35]
    s_waitcnt vmcnt(14)
    v_mfma_f32_16x16x32_bf16 v[16:19], a[140:143], v[196:199], v[16:19]
    buffer_load_dwordx4 v[92:95], v12, s[28:31], s45 offen offset:3072 sc1
    v_mfma_f32_16x16x32_bf16 v[20:23], a[144:147], v[196:199], v[20:23]
    v_add_f32 v200, v200, v204
    v_add_f32 v201, v201, v205
    v_mfma_f32_16x16x32_bf16 v[24:27], a[148:151], v[196:199], v[24:27]
    v_mov_b32 v202, v200
    v_mov_b32 v203, v201
    v_mfma_f32_16x16x32_bf16 v[28:31], a[152:155], v[196:199], v[28:31]
    v_permlane32_swap_b32 v200, v202
    v_permlane32_swap_b32 v201, v203
    v_mfma_f32_16x16x32_bf16 v[32:35], a[156:159], v[196:199], v[32:35]
    s_waitcnt vmcnt(14)
    v_mfma_f32_16x16x32_bf16 v[16:19], a[160:163], v[56:59], v[16:19]
    s_add_u32 s45, s45, 4096
    buffer_load_dwordx4 v[96:99], v12, s[28:31], s45 offen offset:0 sc1
    v_mfma_f32_16x16x32_bf16 v[20:23], a[164:167], v[56:59], v[20:23]
    v_add_f32 v200, v200, v202
    v_add_f32 v201, v201, v203
    v_mfma_f32_16x16x32_bf16 v[24:27], a[168:171], v[56:59], v[24:27]
    v_mov_b32 v202, v200
    v_mov_b32 v203, v201
    v_mfma_f32_16x16x32_bf16 v[28:31], a[172:175], v[56:59], v[28:31]
    v_permlane16_swap_b32 v200, v202
    v_permlane16_swap_b32 v201, v203
    v_mfma_f32_16x16x32_bf16 v[32:35], a[176:179], v[56:59], v[32:35]
    s_waitcnt vmcnt(14)
    v_mfma_f32_16x16x32_bf16 v[16:19], a[180:183], v[60:63], v[16:19]
    buffer_load_dwordx4 v[100:103], v12, s[28:31], s45 offen offset:1024 sc1
    v_mfma_f32_16x16x32_bf16 v[20:23], a[184:187], v[60:63], v[20:23]
    v_add_f32 v200, v200, v202
    v_add_f32 v201, v201, v203
    v_mfma_f32_16x16x32_bf16 v[24:27], a[188:191], v[60:63], v[24:27]
    v_mul_f32 v200, 0x3acccccd, v200
    v_mul_f32 v201, 0x3acccccd, v201
    v_mfma_f32_16x16x32_bf16 v[28:31], a[192:195], v[60:63], v[28:31]
    v_fma_f32 v201, -v200, v200, v201
    v_max_f32 v201, 0, v201
    v_mfma_f32_16x16x32_bf16 v[32:35], a[196:199], v[60:63], v[32:35]
    s_waitcnt vmcnt(14)
    v_mfma_f32_16x16x32_bf16 v[16:19], a[200:203], v[64:67], v[16:19]
    buffer_load_dwordx4 v[104:107], v12, s[28:31], s45 offen offset:2048 sc1
    v_mfma_f32_16x16x32_bf16 v[20:23], a[204:207], v[64:67], v[20:23]
    v_add_f32 v201, 0x3727c5ac, v201
    v_rsq_f32 v10, v201
    v_mfma_f32_16x16x32_bf16 v[24:27], a[208:211], v[64:67], v[24:27]
    v_mfma_f32_16x16x32_bf16 v[28:31], a[212:215], v[64:67], v[28:31]
    v_mfma_f32_16x16x32_bf16 v[32:35], a[216:219], v[64:67], v[32:35]
    s_waitcnt vmcnt(14)
    v_mfma_f32_16x16x32_bf16 v[16:19], a[220:223], v[68:71], v[16:19]
    buffer_load_dwordx4 v[108:111], v12, s[28:31], s45 offen offset:3072 sc1
    v_mfma_f32_16x16x32_bf16 v[20:23], a[224:227], v[68:71], v[20:23]
    v_mfma_f32_16x16x32_bf16 v[24:27], a[228:231], v[68:71], v[24:27]
    v_mfma_f32_16x16x32_bf16 v[28:31], a[232:235], v[68:71], v[28:31]
    v_mfma_f32_16x16x32_bf16 v[32:35], a[236:239], v[68:71], v[32:35]
    s_waitcnt vmcnt(14)
    v_mfma_f32_16x16x32_bf16 v[16:19], a[240:243], v[72:75], v[16:19]
    s_add_u32 s45, s45, 4096
    buffer_load_dwordx4 v[112:115], v12, s[28:31], s45 offen offset:0 sc1
    v_mfma_f32_16x16x32_bf16 v[20:23], a[244:247], v[72:75], v[20:23]
    v_mfma_f32_16x16x32_bf16 v[24:27], a[248:251], v[72:75], v[24:27]
    v_mfma_f32_16x16x32_bf16 v[28:31], a[252:255], v[72:75], v[28:31]
    v_mfma_f32_16x16x32_bf16 v[32:35], v[232:235], v[72:75], v[32:35]
    s_waitcnt vmcnt(14)
    v_mfma_f32_16x16x32_bf16 v[16:19], v[236:239], v[76:79], v[16:19]
    buffer_load_dwordx4 v[116:119], v12, s[28:31], s45 offen offset:1024 sc1
    v_mfma_f32_16x16x32_bf16 v[20:23], v[240:243], v[76:79], v[20:23]
    v_mfma_f32_16x16x32_bf16 v[24:27], v[244:247], v[76:79], v[24:27]
    v_mfma_f32_16x16x32_bf16 v[28:31], v[248:251], v[76:79], v[28:31]
    v_mfma_f32_16x16x32_bf16 v[32:35], v[252:255], v[76:79], v[32:35]
    s_waitcnt vmcnt(14)
    v_mfma_f32_16x16x32_bf16 v[36:39], a[0:3], v[80:83], 0
    buffer_load_dwordx4 v[120:123], v12, s[28:31], s45 offen offset:2048 sc1
    v_mfma_f32_16x16x32_bf16 v[40:43], a[4:7], v[80:83], 0
    v_mfma_f32_16x16x32_bf16 v[44:47], a[8:11], v[80:83], 0
    v_mfma_f32_16x16x32_bf16 v[48:51], a[12:15], v[80:83], 0
    v_mfma_f32_16x16x32_bf16 v[52:55], a[16:19], v[80:83], 0
    s_waitcnt vmcnt(14)
    v_mfma_f32_16x16x32_bf16 v[36:39], a[20:23], v[84:87], v[36:39]
    buffer_load_dwordx4 v[124:127], v12, s[28:31], s45 offen offset:3072 sc1
    s_add_u32 s48, s3, 3
    s_and_b32 s48, s48, 3
    s_mul_i32 s48, s48, 15360
    v_mfma_f32_16x16x32_bf16 v[40:43], a[24:27], v[84:87], v[40:43]
    s_add_u32 s48, s48, 10240
    v_add_u32 v9, s48, v12
    ds_write_b128 v9, v[16:19] offset:0
    v_mfma_f32_16x16x32_bf16 v[44:47], a[28:31], v[84:87], v[44:47]
    ds_write_b128 v9, v[20:23] offset:1024
    v_mfma_f32_16x16x32_bf16 v[48:51], a[32:35], v[84:87], v[48:51]
    ds_write_b128 v9, v[24:27] offset:2048
    v_mfma_f32_16x16x32_bf16 v[52:55], a[36:39], v[84:87], v[52:55]
    s_waitcnt vmcnt(9)
    v_mfma_f32_16x16x32_bf16 v[36:39], a[40:43], v[88:91], v[36:39]
    s_add_u32 s45, s45, 4096
    buffer_load_dwordx4 v[128:131], v13, s[28:31], s45 offen offset:0 sc1
    ds_write_b128 v9, v[28:31] offset:3072
    v_mfma_f32_16x16x32_bf16 v[40:43], a[44:47], v[88:91], v[40:43]
    ds_write_b128 v9, v[32:35] offset:4096
    v_mfma_f32_16x16x32_bf16 v[44:47], a[48:51], v[88:91], v[44:47]
    v_mfma_f32_16x16x32_bf16 v[48:51], a[52:55], v[88:91], v[48:51]
    v_mfma_f32_16x16x32_bf16 v[52:55], a[56:59], v[88:91], v[52:55]
    s_waitcnt vmcnt(9)
    v_mfma_f32_16x16x32_bf16 v[36:39], a[60:63], v[92:95], v[36:39]
    buffer_load_dwordx4 v[132:135], v13, s[28:31], s45 offen offset:1024 sc1
    s_mul_i32 s48, s3, 15360
    s_mov_b32 s50, 0xffff0000
    v_add_u32 v5, s48, v12
    v_mfma_f32_16x16x32_bf16 v[40:43], a[64:67], v[92:95], v[40:43]
    s_waitcnt lgkmcnt(0)
    s_barrier
    ds_read_b128 v[136:139], v5 offset:0
    v_mfma_f32_16x16x32_bf16 v[44:47], a[68:71], v[92:95], v[44:47]
    ds_read_b128 v[156:159], v5 offset:5120
    ds_read_b128 v[176:179], v5 offset:10240
    v_mfma_f32_16x16x32_bf16 v[48:51], a[72:75], v[92:95], v[48:51]
    ds_read_b128 v[140:143], v5 offset:1024
    ds_read_b128 v[160:163], v5 offset:6144
    v_mfma_f32_16x16x32_bf16 v[52:55], a[76:79], v[92:95], v[52:55]
    s_waitcnt vmcnt(9)
    ds_read_b128 v[180:183], v5 offset:11264
    v_mfma_f32_16x16x32_bf16 v[36:39], a[80:83], v[96:99], v[36:39]
    ds_read_b128 v[144:147], v5 offset:2048
    ds_read_b128 v[164:167], v5 offset:7168
    v_mfma_f32_16x16x32_bf16 v[40:43], a[84:87], v[96:99], v[40:43]
    ds_read_b128 v[184:187], v5 offset:12288
    ds_read_b128 v[148:151], v5 offset:3072
    v_mfma_f32_16x16x32_bf16 v[44:47], a[88:91], v[96:99], v[44:47]
    ds_read_b128 v[168:171], v5 offset:8192
    ds_read_b128 v[188:191], v5 offset:13312
    v_mfma_f32_16x16x32_bf16 v[48:51], a[92:95], v[96:99], v[48:51]
    ds_read_b128 v[152:155], v5 offset:4096
    ds_read_b128 v[172:175], v5 offset:9216
    v_mfma_f32_16x16x32_bf16 v[52:55], a[96:99], v[96:99], v[52:55]
    s_waitcnt vmcnt(8)
    ds_read_b128 v[192:195], v5 offset:14336
    v_mfma_f32_16x16x32_bf16 v[36:39], a[100:103], v[100:103], v[36:39]
    s_waitcnt vmcnt(12)
    v_lshlrev_b32 v16, 16, v210
    v_mfma_f32_16x16x32_bf16 v[40:43], a[104:107], v[100:103], v[40:43]
    v_and_b32 v17, s50, v210
    v_lshlrev_b32 v18, 16, v211
    v_mfma_f32_16x16x32_bf16 v[44:47], a[108:111], v[100:103], v[44:47]
    v_and_b32 v19, s50, v211
    s_waitcnt lgkmcnt(12)
    v_mfma_f32_16x16x32_bf16 v[48:51], a[112:115], v[100:103], v[48:51]
    v_add_f32 v136, v136, v156
    v_add_f32 v137, v137, v157
    v_mfma_f32_16x16x32_bf16 v[52:55], a[116:119], v[100:103], v[52:55]
    s_waitcnt vmcnt(7)
    v_add_f32 v138, v138, v158
    v_mfma_f32_16x16x32_bf16 v[36:39], a[120:123], v[104:107], v[36:39]
    v_add_f32 v139, v139, v159
    v_add_f32 v136, v136, v176
    v_mfma_f32_16x16x32_bf16 v[40:43], a[124:127], v[104:107], v[40:43]
    v_add_f32 v137, v137, v177
    v_add_f32 v138, v138, v178
    v_mfma_f32_16x16x32_bf16 v[44:47], a[128:131], v[104:107], v[44:47]
    v_add_f32 v139, v139, v179
    v_fmac_f32 v16, v136, v10
    v_mfma_f32_16x16x32_bf16 v[48:51], a[132:135], v[104:107], v[48:51]
    v_fmac_f32 v17, v137, v10
    v_fmac_f32 v18, v138, v10
    v_mfma_f32_16x16x32_bf16 v[52:55], a[136:139], v[104:107], v[52:55]
    s_waitcnt vmcnt(6)
    v_fmac_f32 v19, v139, v10
    v_mfma_f32_16x16x32_bf16 v[36:39], a[140:143], v[108:111], v[36:39]
    v_lshlrev_b32 v20, 16, v212
    v_and_b32 v21, s50, v212
    v_mfma_f32_16x16x32_bf16 v[40:43], a[144:147], v[108:111], v[40:43]
    v_lshlrev_b32 v22, 16, v213
    v_and_b32 v23, s50, v213
    v_mfma_f32_16x16x32_bf16 v[44:47], a[148:151], v[108:111], v[44:47]
    s_waitcnt lgkmcnt(9)
    v_add_f32 v140, v140, v160
    v_mfma_f32_16x16x32_bf16 v[48:51], a[152:155], v[108:111], v[48:51]
    v_add_f32 v141, v141, v161
    v_add_f32 v142, v142, v162
    v_mfma_f32_16x16x32_bf16 v[52:55], a[156:159], v[108:111], v[52:55]
    s_waitcnt vmcnt(5)
    v_add_f32 v143, v143, v163
    v_mfma_f32_16x16x32_bf16 v[36:39], a[160:163], v[112:115], v[36:39]
    v_add_f32 v140, v140, v180
    v_add_f32 v141, v141, v181
    v_mfma_f32_16x16x32_bf16 v[40:43], a[164:167], v[112:115], v[40:43]
    v_add_f32 v142, v142, v182
    v_add_f32 v143, v143, v183
    v_mfma_f32_16x16x32_bf16 v[44:47], a[168:171], v[112:115], v[44:47]
    v_fmac_f32 v20, v140, v10
    v_fmac_f32 v21, v141, v10
    v_mfma_f32_16x16x32_bf16 v[48:51], a[172:175], v[112:115], v[48:51]
    v_fmac_f32 v22, v142, v10
    v_fmac_f32 v23, v143, v10
    v_mfma_f32_16x16x32_bf16 v[52:55], a[176:179], v[112:115], v[52:55]
    s_waitcnt vmcnt(4)
    v_lshlrev_b32 v24, 16, v214
    v_mfma_f32_16x16x32_bf16 v[36:39], a[180:183], v[116:119], v[36:39]
    v_and_b32 v25, s50, v214
    v_lshlrev_b32 v26, 16, v215
    v_mfma_f32_16x16x32_bf16 v[40:43], a[184:187], v[116:119], v[40:43]
    v_and_b32 v27, s50, v215
    s_waitcnt lgkmcnt(6)
    v_mfma_f32_16x16x32_bf16 v[44:47], a[188:191], v[116:119], v[44:47]
    v_add_f32 v144, v144, v164
    v_add_f32 v145, v145, v165
    v_mfma_f32_16x16x32_bf16 v[48:51], a[192:195], v[116:119], v[48:51]
    v_add_f32 v146, v146, v166
    v_add_f32 v147, v147, v167
    v_mfma_f32_16x16x32_bf16 v[52:55], a[196:199], v[116:119], v[52:55]
    s_waitcnt vmcnt(3)
    v_add_f32 v144, v144, v184
    v_mfma_f32_16x16x32_bf16 v[36:39], a[200:203], v[120:123], v[36:39]
    v_add_f32 v145, v145, v185
    v_add_f32 v146, v146, v186
    v_mfma_f32_16x16x32_bf16 v[40:43], a[204:207], v[120:123], v[40:43]
    v_add_f32 v147, v147, v187
    v_fmac_f32 v24, v144, v10
    v_mfma_f32_16x16x32_bf16 v[44:47], a[208:211], v[120:123], v[44:47]
    v_fmac_f32 v25, v145, v10
    v_fmac_f32 v26, v146, v10
    v_mfma_f32_16x16x32_bf16 v[48:51], a[212:215], v[120:123], v[48:51]
    v_fmac_f32 v27, v147, v10
    v_lshlrev_b32 v28, 16, v216
    v_mfma_f32_16x16x32_bf16 v[52:55], a[216:219], v[120:123], v[52:55]
    s_waitcnt vmcnt(2)
    v_and_b32 v29, s50, v216
    v_mfma_f32_16x16x32_bf16 v[36:39], a[220:223], v[124:127], v[36:39]
    v_lshlrev_b32 v30, 16, v217
    v_and_b32 v31, s50, v217
    v_mfma_f32_16x16x32_bf16 v[40:43], a[224:227], v[124:127], v[40:43]
    s_waitcnt lgkmcnt(3)
    v_add_f32 v148, v148, v168
    v_mfma_f32_16x16x32_bf16 v[44:47], a[228:231], v[124:127], v[44:47]
    v_add_f32 v149, v149, v169
    v_add_f32 v150, v150, v170
    v_mfma_f32_16x16x32_bf16 v[48:51], a[232:235], v[124:127], v[48:51]
    v_add_f32 v151, v151, v171
    v_add_f32 v148, v148, v188
    v_mfma_f32_16x16x32_bf16 v[52:55], a[236:239], v[124:127], v[52:55]
    s_waitcnt vmcnt(1)
    v_add_f32 v149, v149, v189
    v_mfma_f32_16x16x32_bf16 v[36:39], a[240:243], v[128:131], v[36:39]
    v_add_f32 v150, v150, v190
    v_add_f32 v151, v151, v191
    v_mfma_f32_16x16x32_bf16 v[40:43], a[244:247], v[128:131], v[40:43]
    v_fmac_f32 v28, v148, v10
    v_fmac_f32 v29, v149, v10
    v_mfma_f32_16x16x32_bf16 v[44:47], a[248:251], v[128:131], v[44:47]
    v_fmac_f32 v30, v150, v10
    v_fmac_f32 v31, v151, v10
    v_mfma_f32_16x16x32_bf16 v[48:51], a[252:255], v[128:131], v[48:51]
    v_lshlrev_b32 v32, 16, v218
    v_and_b32 v33, s50, v218
    v_mfma_f32_16x16x32_bf16 v[52:55], v[232:235], v[128:131], v[52:55]
    s_waitcnt vmcnt(0)
    v_lshlrev_b32 v34, 16, v219
    v_mfma_f32_16x16x32_bf16 v[36:39], v[236:239], v[132:135], v[36:39]
    v_and_b32 v35, s50, v219
    s_waitcnt lgkmcnt(0)
    v_mfma_f32_16x16x32_bf16 v[40:43], v[240:243], v[132:135], v[40:43]
    v_add_f32 v152, v152, v172
    v_add_f32 v153, v153, v173
    v_mfma_f32_16x16x32_bf16 v[44:47], v[244:247], v[132:135], v[44:47]
    v_add_f32 v154, v154, v174
    v_add_f32 v155, v155, v175
    v_mfma_f32_16x16x32_bf16 v[48:51], v[248:251], v[132:135], v[48:51]
    v_add_f32 v152, v152, v192
    v_add_f32 v153, v153, v193
    v_mfma_f32_16x16x32_bf16 v[52:55], v[252:255], v[132:135], v[52:55]
    v_add_f32 v154, v154, v194
    v_add_f32 v155, v155, v195
    v_fmac_f32 v32, v152, v10
    v_fmac_f32 v33, v153, v10
    v_fmac_f32 v34, v154, v10
    v_fmac_f32 v35, v155, v10
    s_mul_i32 s47, s19, 1280
    s_mul_i32 s49, s20, 160
    s_add_u32 s47, s47, s49
    s_mul_i32 s49, s3, 655360
    s_add_u32 s47, s47, s49
    v_pk_fma_f32 v[16:17], v[36:37], v[10:11], v[16:17] op_sel_hi:[1,0,1]
    v_pk_fma_f32 v[18:19], v[38:39], v[10:11], v[18:19] op_sel_hi:[1,0,1]
    v_cvt_pk_bf16_f32 v16, v16, v17
    v_cvt_pk_bf16_f32 v17, v18, v19
    ds_write_b64 v226, v[16:17] offset:0
    v_pk_fma_f32 v[20:21], v[40:41], v[10:11], v[20:21] op_sel_hi:[1,0,1]
    v_pk_fma_f32 v[22:23], v[42:43], v[10:11], v[22:23] op_sel_hi:[1,0,1]
    v_cvt_pk_bf16_f32 v20, v20, v21
    v_cvt_pk_bf16_f32 v21, v22, v23
    ds_write_b64 v226, v[20:21] offset:32
    v_pk_fma_f32 v[24:25], v[44:45], v[10:11], v[24:25] op_sel_hi:[1,0,1]
    v_pk_fma_f32 v[26:27], v[46:47], v[10:11], v[26:27] op_sel_hi:[1,0,1]
    v_cvt_pk_bf16_f32 v24, v24, v25
    v_cvt_pk_bf16_f32 v25, v26, v27
    ds_write_b64 v226, v[24:25] offset:64
    v_pk_fma_f32 v[28:29], v[48:49], v[10:11], v[28:29] op_sel_hi:[1,0,1]
    v_pk_fma_f32 v[30:31], v[50:51], v[10:11], v[30:31] op_sel_hi:[1,0,1]
    v_cvt_pk_bf16_f32 v28, v28, v29
    v_cvt_pk_bf16_f32 v29, v30, v31
    ds_write_b64 v226, v[28:29] offset:96
    v_pk_fma_f32 v[32:33], v[52:53], v[10:11], v[32:33] op_sel_hi:[1,0,1]
    v_pk_fma_f32 v[34:35], v[54:55], v[10:11], v[34:35] op_sel_hi:[1,0,1]
    v_cvt_pk_bf16_f32 v32, v32, v33
    v_cvt_pk_bf16_f32 v33, v34, v35
    ds_write_b64 v226, v[32:33] offset:128
    s_waitcnt lgkmcnt(0)
    ds_read_b128 v[60:63], v220
    ds_read_b128 v[64:67], v221
    ds_read_b128 v[68:71], v222
    s_waitcnt lgkmcnt(2)
    buffer_store_dwordx4 v[60:63], v223, s[32:35], s47 offen
    s_waitcnt lgkmcnt(1)
    buffer_store_dwordx4 v[64:67], v224, s[32:35], s47 offen
    s_waitcnt lgkmcnt(0)
    buffer_store_dwordx4 v[68:71], v225, s[32:35], s47 offen
    s_or_b32 s47, s2, s3
    s_cmp_lg_u32 s47, 0
    s_cbranch_scc1 L_notag
    s_mov_b32 s47, 26476544
    v_mov_b32 v8, s24
    v_mov_b32 v9, s25
    v_mov_b32 v10, 0
    s_mov_b64 exec, 1
    buffer_store_dwordx2 v[8:9], v10, s[28:31], s47 offen sc1
    s_mov_b64 exec, -1
L_notag:
L_end:
    s_endpgm
.section .rodata,"a"
.p2align 6
.amdhsa_kernel sequential_preLN__spectral_fnet__dense_activation_relu__prompt_kernel
  .amdhsa_next_free_vgpr 512
  .amdhsa_next_free_sgpr 102
  .amdhsa_accum_offset 256
  .amdhsa_group_segment_fixed_size 0
  .amdhsa_kernarg_size 88
  .amdhsa_user_sgpr_count 2
  .amdhsa_user_sgpr_kernarg_segment_ptr 1
  .amdhsa_system_sgpr_workgroup_id_x 1
.end_amdhsa_kernel
```
